```python
import torch

def _softmax(x, axis=-1):
    return torch.softmax(x, dim=axis)
def _gelu(x):
    return torch.nn.functional.gelu(x, approximate="tanh")
def _silu(x):
    return torch.nn.functional.silu(x)
def _sigmoid(x):
    return torch.sigmoid(x)
def _layernorm(x, axis=-1, eps=1e-5):
    m = x.mean(dim=axis, keepdim=True)
    v = x.var(dim=axis, keepdim=True, unbiased=False)
    return (x - m) / torch.sqrt(v + eps)
def _scatter_add(tgt, idx, src, axis=0):
    return tgt.clone().index_add_(axis, idx, src)
def _segment_sum(src, seg, n):
    out = torch.zeros((n,) + src.shape[1:], dtype=src.dtype)
    return out.index_add_(0, seg, src)
def _pad(x, pw):
    flat = tuple(v for pair in reversed(pw) for v in pair)
    return torch.nn.functional.pad(x, flat)

kernel_name = 'parallel_sum__sliding_local_dilated__glu_gated_geglu__prompt'

def setup_inputs():

    _w = (lambda a: (lambda t: t.to(torch.bfloat16) if t.is_floating_point() else t)(torch.as_tensor(a)))
    def _A_setup():
        B, S, D = 1, 2048, 640
        return {
            "x": _w((lambda *s: torch.randn(*s, dtype=torch.bfloat16) * 0.05)(B, S, D)),
            "wqkv": _w((lambda *s: torch.randn(*s, dtype=torch.bfloat16) * 0.05)(D, 3 * D)),
            "wo": _w((lambda *s: torch.randn(*s, dtype=torch.bfloat16) * 0.05)(D, D)),
        }
    _A_in = _A_setup()

    def _B_setup():
        B, S, Dm, Df = 1, 2048, 640, 1728
        return {
            "x": _w((lambda *s: torch.randn(*s, dtype=torch.bfloat16) * 0.05)(B, S, Dm)),
            "w_gate": _w((lambda *s: torch.randn(*s, dtype=torch.bfloat16) * 0.8)(Dm, Df) * (Dm ** -0.5)),
            "w_up": _w((lambda *s: torch.randn(*s, dtype=torch.bfloat16) * 0.8)(Dm, Df) * (Dm ** -0.5)),
            "w_down": _w((lambda *s: torch.randn(*s, dtype=torch.bfloat16) * 0.8)(Df, Dm) * (Df ** -0.5)),
        }
    _B_in = _B_setup()

    return {
        "A_x": _A_in["x"],
        "A_wqkv": _A_in["wqkv"],
        "A_wo": _A_in["wo"],
        "B_x": _B_in["x"],
        "B_w_gate": _B_in["w_gate"],
        "B_w_up": _B_in["w_up"],
        "B_w_down": _B_in["w_down"],
    }

def reference(A_x, A_wqkv, A_wo, B_x, B_w_gate, B_w_up, B_w_down):
    def _A_ref(x, wqkv, wo):
        B, S, D = x.shape
        H = 32; Dh = D // H
        W, dil = 8, 2
        qkv = (lambda x, *d: x.permute(*d))((x @ wqkv).reshape(B, S, 3, H, Dh), 2, 0, 3, 1, 4)
        q, k, v = qkv[0], qkv[1], qkv[2]
        scale = Dh ** -0.5
        pos = torch.arange(S)
        off = torch.arange(W) * dil
        idx = pos[:, None] - off[None, :]
        mask = idx >= 0
        idx_c = torch.where(mask, idx, 0).reshape(-1)
        kg = k[:, :, idx_c, :].reshape(B, H, S, W, Dh)
        vg = v[:, :, idx_c, :].reshape(B, H, S, W, Dh)
        logits = torch.einsum("bhsd,bhswd->bhsw", q, kg) * scale
        logits = torch.where(mask[None, None, :, :], logits, -1e9)
        attn = _softmax(logits, axis=-1)
        o = torch.einsum("bhsw,bhswd->bhsd", attn, vg)
        return (lambda x, *d: x.permute(*d))(o, 0, 2, 1, 3).reshape(B, S, D) @ wo

    def _B_ref(x, w_gate, w_up, w_down):
        g = torch.einsum("bsd,df->bsf", x, w_gate)
        u = torch.einsum("bsd,df->bsf", x, w_up)
        h = _gelu(g) * u
        return torch.einsum("bsf,fd->bsd", h, w_down)

    x = A_x
    xn = _layernorm(x, axis=-1)
    return x + _A_ref(xn, A_wqkv, A_wo) + _B_ref(xn, B_w_gate, B_w_up, B_w_down)
```

```asm
; @launch grid=(256,1,1) block=(512,1,1) lds=163840
.amdgcn_target "amdgcn-amd-amdhsa--gfx950"
.text
.globl parallel_sum__sliding_local_dilated__glu_gated_geglu__prompt_kernel
.type parallel_sum__sliding_local_dilated__glu_gated_geglu__prompt_kernel,@function
.p2align 8
parallel_sum__sliding_local_dilated__glu_gated_geglu__prompt_kernel:
    s_cmp_ge_u32 s2, 256
    s_cbranch_scc1 K1_END
    s_load_dwordx4 s[24:27], s[0:1], 0
    s_load_dwordx2 s[28:29], s[0:1], 16
    s_load_dwordx4 s[32:35], s[0:1], 32
    s_load_dwordx4 s[36:39], s[0:1], 48
    s_load_dwordx4 s[4:7], s[0:1], 64
    v_lshrrev_b32 v24, 6, v0
    v_and_b32 v1, 63, v0
    v_readfirstlane_b32 s40, v24
    v_and_b32 v2, 31, v0
    v_bfe_u32 v3, v0, 5, 1
    s_movk_i32 s74, 0x7ff
    s_and_b32 s60, s2, 7
    s_lshr_b32 s61, s2, 3
    s_and_b32 s62, s60, 1
    s_lshr_b32 s63, s60, 1
    s_lshr_b32 s41, s40, 1
    s_and_b32 s42, s40, 1
    s_and_b32 s43, s41, 1
    s_cmp_lt_u32 s61, 18
    s_cbranch_scc0 K1_NOTFF
    s_mul_i32 s60, s63, 18
    s_add_u32 s60, s60, s61
    s_lshr_b32 s45, s60, 2
    s_and_b32 s60, s60, 3
    s_lshl_b32 s62, s62, 2
    s_add_u32 s60, s60, s62
    s_lshl_b32 s46, s60, 8
    s_mov_b32 s44, 0
    s_movk_i32 s47, 3456
    s_mov_b32 s48, 0
    s_mov_b32 s49, 0
    s_mul_i32 s50, s45, 192
    s_waitcnt lgkmcnt(0)
    s_mov_b32 s12, s32
    s_and_b32 s13, s33, 0xffff
    s_mov_b32 s14, 2211840
    s_mov_b32 s15, 0x00020000
    s_mov_b32 s16, s34
    s_and_b32 s17, s35, 0xffff
    s_mov_b32 s18, 2211840
    s_mov_b32 s19, 0x00020000
    s_branch K1_COMMON
K1_NOTFF:
    s_mul_i32 s60, s63, 14
    s_add_u32 s60, s60, s61
    s_sub_u32 s60, s60, 18
    s_cmp_eq_u32 s62, 0
    s_cbranch_scc0 K1_MH1
    s_mov_b32 s61, 0
    s_cmp_lt_u32 s60, 55
    s_cbranch_scc0 K1_SPARE
    s_mul_i32 s45, s60, 205
    s_lshr_b32 s45, s45, 10
    s_mul_i32 s61, s45, 5
    s_sub_u32 s61, s60, s61
    s_branch K1_ATT
K1_MH1:
    s_sub_u32 s61, s60, 43
    s_cmp_lt_u32 s60, 44
    s_cbranch_scc0 K1_SPARE
    s_lshr_b32 s45, s60, 2
    s_and_b32 s61, s60, 3
    s_add_u32 s61, s61, 5
K1_ATT:
    s_mul_i32 s46, s61, 240
    s_sub_u32 s46, s46, 16
    s_mov_b32 s44, 1
    s_movk_i32 s47, 3840
    s_movk_i32 s48, 1152
    s_movk_i32 s49, 1344
    s_mul_i32 s50, s45, 120
    s_waitcnt lgkmcnt(0)
    s_mov_b32 s12, s26
    s_and_b32 s13, s27, 0xffff
    s_mov_b32 s14, 2457600
    s_mov_b32 s15, 0x00020000
    s_mov_b32 s16, s26
    s_and_b32 s17, s27, 0xffff
    s_mov_b32 s18, 2457600
    s_mov_b32 s19, 0x00020000
K1_COMMON:
    s_mov_b32 s8, s24
    s_and_b32 s9, s25, 0xffff
    s_mov_b32 s10, 2621440
    s_mov_b32 s11, 0x00020000
    s_mov_b32 s20, s6
    s_and_b32 s21, s7, 0xffff
    s_mov_b32 s22, 13632000
    s_mov_b32 s23, 0x00020000
    s_mov_b32 s52, 0
    s_mov_b32 s53, 0
    s_cmp_lt_u32 s40, 4
    s_cbranch_scc0 K1_PFSETUP
    v_lshrrev_b32 v24, 3, v1
    v_and_b32 v25, 7, v1
    v_bfe_u32 v27, v24, 1, 2
    v_xor_b32 v27, v27, v25
    v_lshlrev_b32 v27, 4, v27
    v_xor_b32 v28, 64, v27
    s_lshl_b32 s60, s40, 6
    s_add_i32 s60, s60, s46
    s_movk_i32 s61, 1280
    v_add_u32 v24, s60, v24
    s_lshl_b32 s55, s40, 13
    v_add_u32 v26, 0, v24
    v_med3_i32 v26, v26, 0, s74
    v_mad_u32_u24 v72, v26, s61, v27
    v_add_u32 v26, 8, v24
    v_med3_i32 v26, v26, 0, s74
    v_mad_u32_u24 v73, v26, s61, v28
    v_add_u32 v26, 16, v24
    v_med3_i32 v26, v26, 0, s74
    v_mad_u32_u24 v74, v26, s61, v27
    v_add_u32 v26, 24, v24
    v_med3_i32 v26, v26, 0, s74
    v_mad_u32_u24 v75, v26, s61, v28
    v_add_u32 v26, 32, v24
    v_med3_i32 v26, v26, 0, s74
    v_mad_u32_u24 v76, v26, s61, v27
    v_add_u32 v26, 40, v24
    v_med3_i32 v26, v26, 0, s74
    v_mad_u32_u24 v77, v26, s61, v28
    v_add_u32 v26, 48, v24
    v_med3_i32 v26, v26, 0, s74
    v_mad_u32_u24 v78, v26, s61, v27
    v_add_u32 v26, 56, v24
    v_med3_i32 v26, v26, 0, s74
    v_mad_u32_u24 v79, v26, s61, v28
    s_mov_b32 m0, s55
    s_nop 0
    buffer_load_dwordx4 v72, s[8:11], s52 offen lds
    s_add_u32 m0, s55, 1024
    s_nop 0
    buffer_load_dwordx4 v73, s[8:11], s52 offen lds
    s_add_u32 m0, s55, 2048
    s_nop 0
    buffer_load_dwordx4 v74, s[8:11], s52 offen lds
    s_add_u32 m0, s55, 3072
    s_nop 0
    buffer_load_dwordx4 v75, s[8:11], s52 offen lds
    s_add_u32 m0, s55, 4096
    s_nop 0
    buffer_load_dwordx4 v76, s[8:11], s52 offen lds
    s_add_u32 m0, s55, 5120
    s_nop 0
    buffer_load_dwordx4 v77, s[8:11], s52 offen lds
    s_add_u32 m0, s55, 6144
    s_nop 0
    buffer_load_dwordx4 v78, s[8:11], s52 offen lds
    s_add_u32 m0, s55, 7168
    s_nop 0
    buffer_load_dwordx4 v79, s[8:11], s52 offen lds
    s_add_u32 s55, s55, 32768
    s_add_u32 s52, s52, 128
    s_cmp_ge_u32 s55, 98304
    s_cselect_b32 s60, 98304, 0
    s_sub_u32 s55, s55, s60
    s_and_b32 s60, s40, 1
    s_mul_i32 s60, s60, 192
    s_lshr_b32 s62, s40, 1
    s_mul_i32 s56, s62, 6176
    s_lshl_b32 s63, s60, 4
    s_add_u32 s56, s56, s63
    s_add_u32 s56, s56, 98304
    s_mul_i32 s63, s62, s49
    s_add_u32 s50, s50, s63
    s_lshr_b32 s63, 8, s62
    s_cmp_eq_u32 s62, 0
    s_cselect_b32 s12, s12, s16
    s_cselect_b32 s13, s13, s17
    s_lshl_b32 s54, s47, 5
    v_mov_b32 v28, s48
    v_add_u32 v24, s60, v1
    v_mul_u32_u24 v25, 0xaab, v24
    v_lshrrev_b32 v25, 15, v25
    v_mul_u32_u24 v26, 12, v25
    v_sub_u32 v24, v24, v26
    v_cmp_le_u32 vcc, s63, v24
    v_mul_lo_u32 v25, v25, s47
    v_lshl_add_u32 v25, v24, 4, v25
    v_cndmask_b32 v26, 0, v28, vcc
    v_add3_u32 v80, v25, v26, s50
    v_add_u32 v24, s60, v1
    v_add_u32 v24, 64, v24
    v_mul_u32_u24 v25, 0xaab, v24
    v_lshrrev_b32 v25, 15, v25
    v_mul_u32_u24 v26, 12, v25
    v_sub_u32 v24, v24, v26
    v_cmp_le_u32 vcc, s63, v24
    v_mul_lo_u32 v25, v25, s47
    v_lshl_add_u32 v25, v24, 4, v25
    v_cndmask_b32 v26, 0, v28, vcc
    v_add3_u32 v81, v25, v26, s50
    v_add_u32 v24, s60, v1
    v_add_u32 v24, 128, v24
    v_mul_u32_u24 v25, 0xaab, v24
    v_lshrrev_b32 v25, 15, v25
    v_mul_u32_u24 v26, 12, v25
    v_sub_u32 v24, v24, v26
    v_cmp_le_u32 vcc, s63, v24
    v_mul_lo_u32 v25, v25, s47
    v_lshl_add_u32 v25, v24, 4, v25
    v_cndmask_b32 v26, 0, v28, vcc
    v_add3_u32 v82, v25, v26, s50
    s_mov_b32 m0, s56
    s_nop 0
    buffer_load_dwordx4 v80, s[12:15], s53 offen lds
    s_add_u32 m0, s56, 1024
    s_nop 0
    buffer_load_dwordx4 v81, s[12:15], s53 offen lds
    s_add_u32 m0, s56, 2048
    s_nop 0
    buffer_load_dwordx4 v82, s[12:15], s53 offen lds
    s_add_u32 s56, s56, 12352
    s_add_u32 s53, s53, s54
    s_cmp_ge_u32 s56, 160064
    s_cselect_b32 s60, 61760, 0
    s_sub_u32 s56, s56, s60
    s_mov_b32 m0, s56
    s_nop 0
    buffer_load_dwordx4 v80, s[12:15], s53 offen lds
    s_add_u32 m0, s56, 1024
    s_nop 0
    buffer_load_dwordx4 v81, s[12:15], s53 offen lds
    s_add_u32 m0, s56, 2048
    s_nop 0
    buffer_load_dwordx4 v82, s[12:15], s53 offen lds
    s_add_u32 s56, s56, 12352
    s_add_u32 s53, s53, s54
    s_cmp_ge_u32 s56, 160064
    s_cselect_b32 s60, 61760, 0
    s_sub_u32 s56, s56, s60
    s_mov_b32 m0, s55
    s_nop 0
    buffer_load_dwordx4 v72, s[8:11], s52 offen lds
    s_add_u32 m0, s55, 1024
    s_nop 0
    buffer_load_dwordx4 v73, s[8:11], s52 offen lds
    s_add_u32 m0, s55, 2048
    s_nop 0
    buffer_load_dwordx4 v74, s[8:11], s52 offen lds
    s_add_u32 m0, s55, 3072
    s_nop 0
    buffer_load_dwordx4 v75, s[8:11], s52 offen lds
    s_add_u32 m0, s55, 4096
    s_nop 0
    buffer_load_dwordx4 v76, s[8:11], s52 offen lds
    s_add_u32 m0, s55, 5120
    s_nop 0
    buffer_load_dwordx4 v77, s[8:11], s52 offen lds
    s_add_u32 m0, s55, 6144
    s_nop 0
    buffer_load_dwordx4 v78, s[8:11], s52 offen lds
    s_add_u32 m0, s55, 7168
    s_nop 0
    buffer_load_dwordx4 v79, s[8:11], s52 offen lds
    s_add_u32 s55, s55, 32768
    s_add_u32 s52, s52, 128
    s_cmp_ge_u32 s55, 98304
    s_cselect_b32 s60, 98304, 0
    s_sub_u32 s55, s55, s60
    s_mov_b32 m0, s56
    s_nop 0
    buffer_load_dwordx4 v80, s[12:15], s53 offen lds
    s_add_u32 m0, s56, 1024
    s_nop 0
    buffer_load_dwordx4 v81, s[12:15], s53 offen lds
    s_add_u32 m0, s56, 2048
    s_nop 0
    buffer_load_dwordx4 v82, s[12:15], s53 offen lds
    s_add_u32 s56, s56, 12352
    s_add_u32 s53, s53, s54
    s_cmp_ge_u32 s56, 160064
    s_cselect_b32 s60, 61760, 0
    s_sub_u32 s56, s56, s60
    s_mov_b32 m0, s56
    s_nop 0
    buffer_load_dwordx4 v80, s[12:15], s53 offen lds
    s_add_u32 m0, s56, 1024
    s_nop 0
    buffer_load_dwordx4 v81, s[12:15], s53 offen lds
    s_add_u32 m0, s56, 2048
    s_nop 0
    buffer_load_dwordx4 v82, s[12:15], s53 offen lds
    s_add_u32 s56, s56, 12352
    s_add_u32 s53, s53, s54
    s_cmp_ge_u32 s56, 160064
    s_cselect_b32 s60, 61760, 0
    s_sub_u32 s56, s56, s60
    v_mov_b32 v83, 0x7f000000
    s_mov_b32 s76, s4
    s_and_b32 s77, s5, 0xffff
    s_mov_b32 s78, 256
    s_mov_b32 s79, 0x00020000
    s_mov_b32 s73, 0
    s_branch K1_SETUP2
K1_PFSETUP:
    s_sleep 16
    s_mul_i32 s60, s2, 171
    s_lshr_b32 s60, s60, 9
    s_mul_i32 s61, s60, 3
    s_sub_u32 s61, s2, s61
    s_mul_i32 s73, s61, 5504
    s_lshl_b32 s62, s60, 6
    s_add_u32 s73, s73, s62
    s_lshl_b32 s73, s73, 2
    s_add_u32 s73, s73, 13516800
    s_movk_i32 s62, 3456
    s_mov_b32 s78, 2211840
    s_cmp_lt_u32 s60, 27
    s_cselect_b32 s76, s32, s34
    s_cselect_b32 s77, s33, s35
    s_cselect_b32 s63, 0, 27
    s_cmp_lt_u32 s60, 54
    s_cselect_b32 s76, s76, s26
    s_cselect_b32 s77, s77, s27
    s_cselect_b32 s63, s63, 54
    s_cselect_b32 s62, s62, 3840
    s_cselect_b32 s78, s78, 2457600
    s_and_b32 s77, s77, 0xffff
    s_mov_b32 s79, 0x00020000
    s_sub_u32 s60, s60, s63
    s_lshl_b32 s60, s60, 7
    s_mul_i32 s61, s61, 224
    s_lshl_b32 s63, s40, 3
    s_add_u32 s61, s61, s63
    s_sub_u32 s61, s61, 32
    v_lshrrev_b32 v64, 3, v1
    v_add_u32 v64, s61, v64
    v_mul_lo_u32 v64, v64, s62
    v_and_b32 v65, 7, v1
    v_lshl_add_u32 v64, v65, 4, v64
    s_lshl_b32 s62, s62, 5
    buffer_load_dwordx4 v[24:27], v64, s[76:79], s60 offen
    s_add_u32 s60, s60, s62
    buffer_load_dwordx4 v[28:31], v64, s[76:79], s60 offen
    s_add_u32 s60, s60, s62
    buffer_load_dwordx4 v[32:35], v64, s[76:79], s60 offen
    s_add_u32 s60, s60, s62
    buffer_load_dwordx4 v[36:39], v64, s[76:79], s60 offen
    s_add_u32 s60, s60, s62
    buffer_load_dwordx4 v[40:43], v64, s[76:79], s60 offen
    s_add_u32 s60, s60, s62
    buffer_load_dwordx4 v[44:47], v64, s[76:79], s60 offen
    s_add_u32 s60, s60, s62
    buffer_load_dwordx4 v[48:51], v64, s[76:79], s60 offen
    s_lshl_b32 s60, s2, 2
    s_add_u32 s60, s60, s40
    s_sub_u32 s60, s60, 4
    s_mul_i32 s60, s60, 2560
    v_mul_u32_u24 v65, 1280, v3
    v_lshl_add_u32 v65, v2, 4, v65
    v_lshrrev_b32 v66, 4, v2
    v_lshl_add_u32 v66, v66, 30, v65
    buffer_load_dwordx4 v[52:55], v65, s[8:11], s60 offen
    buffer_load_dwordx4 v[56:59], v65, s[8:11], s60 offen offset:512
    buffer_load_dwordx4 v[60:63], v66, s[8:11], s60 offen offset:1024
    s_and_b32 s60, s2, 7
    s_lshr_b32 s61, s2, 3
    s_and_b32 s62, s60, 1
    s_lshr_b32 s63, s60, 1
    s_cmp_eq_u32 s40, 4
    s_cbranch_scc0 K1_PF_W0
    s_mov_b32 s16, s24
    s_and_b32 s17, s25, 0xffff
    s_mov_b32 s18, 2621440
    s_mov_b32 s19, 0x00020000
    s_lshl_b32 s62, s62, 10
    s_mul_i32 s61, s61, 40
    s_add_u32 s61, s61, s62
    v_add_u32 v64, s61, v1
    v_mul_u32_u24 v83, 1280, v64
    v_cmp_gt_u32 vcc, 40, v1
    s_movk_i32 s75, 128
    s_movk_i32 s52, 256
    s_branch K1_PF_E0
K1_PF_W0:
    s_cmp_eq_u32 s40, 7
    s_cbranch_scc1 K1_PF_Q0
    s_cmp_eq_u32 s40, 5
    s_cselect_b32 s16, s32, s34
    s_cselect_b32 s17, s33, s35
    s_mov_b32 s16, s16
    s_and_b32 s17, s17, 0xffff
    s_mov_b32 s18, 2211840
    s_mov_b32 s19, 0x00020000
    s_mul_i32 s63, s63, 18
    s_lshr_b32 s63, s63, 2
    s_mul_i32 s63, s63, 192
    s_mul_i32 s61, s61, 6912
    s_add_u32 s61, s61, s63
    v_lshrrev_b32 v64, 4, v1
    v_and_b32 v65, 15, v1
    v_mul_u32_u24 v66, 3456, v64
    v_lshl_add_u32 v66, v65, 7, v66
    v_add_u32 v83, s61, v66
    v_lshl_add_u32 v64, v64, 3, v65
    v_cmp_gt_u32 vcc, 8, v65
    v_cmp_gt_u32 s[62:63], 32, v1
    s_and_b64 vcc, vcc, s[62:63]
    s_mov_b32 s75, 221184
    s_mov_b32 s52, 442368
    s_branch K1_PF_E0
K1_PF_Q0:
    s_mov_b32 s16, s26
    s_and_b32 s17, s27, 0xffff
    s_mov_b32 s18, 2457600
    s_mov_b32 s19, 0x00020000
    s_mul_i32 s63, s63, 14
    s_mul_i32 s60, s63, 205
    s_lshr_b32 s60, s60, 10
    s_lshr_b32 s63, s63, 2
    s_cmp_eq_u32 s62, 0
    s_cselect_b32 s63, s60, s63
    s_mul_i32 s63, s63, 120
    s_mul_i32 s61, s61, 7680
    s_add_u32 s61, s61, s63
    v_lshrrev_b32 v64, 3, v1
    v_and_b32 v65, 7, v1
    v_mul_u32_u24 v66, 1280, v64
    v_lshl_add_u32 v66, v65, 7, v66
    v_add_u32 v83, s61, v66
    v_cmp_gt_u32 vcc, 5, v65
    v_cmp_gt_u32 s[62:63], 48, v1
    s_and_b64 vcc, vcc, s[62:63]
    s_mov_b32 s75, 245760
    s_mov_b32 s52, 491520
K1_PF_E0:
    v_mov_b32 v64, 0x7f000000
    v_cndmask_b32 v83, v64, v83, vcc
    v_mov_b32 v72, 0x7f000000
    v_mov_b32 v73, 0x7f000000
    v_mov_b32 v74, 0x7f000000
    v_mov_b32 v75, 0x7f000000
    v_mov_b32 v76, 0x7f000000
    v_mov_b32 v77, 0x7f000000
    v_mov_b32 v78, 0x7f000000
    v_mov_b32 v79, 0x7f000000
    v_mov_b32 v80, 0x7f000000
    v_mov_b32 v81, 0x7f000000
    v_mov_b32 v82, 0x7f000000
K1_SETUP2:
    s_mov_b64 s[68:69], exec
    v_bfe_u32 v64, v2, 1, 3
    v_xor_b32 v64, v64, v3
    s_lshl_b32 s60, s43, 1
    v_xor_b32 v64, s60, v64
    v_lshlrev_b32 v64, 4, v64
    v_lshl_add_u32 v64, v2, 7, v64
    s_lshl_b32 s60, s40, 12
    v_add_u32 v21, s60, v64
    v_add_u32 v10, s60, v64
    v_bfe_u32 v64, v1, 4, 1
    v_mul_u32_u24 v64, 6176, v64
    v_bfe_u32 v65, v1, 2, 2
    v_lshl_add_u32 v65, v3, 3, v65
    v_mul_u32_u24 v65, 192, v65
    v_add_u32 v64, v64, v65
    v_and_b32 v65, 1, v1
    v_lshl_add_u32 v64, v65, 4, v64
    v_bfe_u32 v65, v1, 1, 1
    v_lshl_add_u32 v64, v65, 3, v64
    s_mul_i32 s60, s42, 96
    s_add_u32 s60, s60, 98304
    s_mul_i32 s61, s43, 3072
    s_add_u32 s62, s60, s61
    v_add_u32 v22, s62, v64
    v_add_u32 v11, s62, v64
    s_sub_u32 s62, s60, s61
    s_add_u32 s62, s62, 3072
    v_add_u32 v23, s62, v64
    s_mov_b32 s57, 0
    s_mov_b32 s58, 0
    v_mov_b32 v128, 0
    v_mov_b32 v129, 0
    v_mov_b32 v130, 0
    v_mov_b32 v131, 0
    v_mov_b32 v132, 0
    v_mov_b32 v133, 0
    v_mov_b32 v134, 0
    v_mov_b32 v135, 0
    v_mov_b32 v136, 0
    v_mov_b32 v137, 0
    v_mov_b32 v138, 0
    v_mov_b32 v139, 0
    v_mov_b32 v140, 0
    v_mov_b32 v141, 0
    v_mov_b32 v142, 0
    v_mov_b32 v143, 0
    v_mov_b32 v144, 0
    v_mov_b32 v145, 0
    v_mov_b32 v146, 0
    v_mov_b32 v147, 0
    v_mov_b32 v148, 0
    v_mov_b32 v149, 0
    v_mov_b32 v150, 0
    v_mov_b32 v151, 0
    v_mov_b32 v152, 0
    v_mov_b32 v153, 0
    v_mov_b32 v154, 0
    v_mov_b32 v155, 0
    v_mov_b32 v156, 0
    v_mov_b32 v157, 0
    v_mov_b32 v158, 0
    v_mov_b32 v159, 0
    v_mov_b32 v160, 0
    v_mov_b32 v161, 0
    v_mov_b32 v162, 0
    v_mov_b32 v163, 0
    v_mov_b32 v164, 0
    v_mov_b32 v165, 0
    v_mov_b32 v166, 0
    v_mov_b32 v167, 0
    v_mov_b32 v168, 0
    v_mov_b32 v169, 0
    v_mov_b32 v170, 0
    v_mov_b32 v171, 0
    v_mov_b32 v172, 0
    v_mov_b32 v173, 0
    v_mov_b32 v174, 0
    v_mov_b32 v175, 0
    v_mov_b32 v176, 0
    v_mov_b32 v177, 0
    v_mov_b32 v178, 0
    v_mov_b32 v179, 0
    v_mov_b32 v180, 0
    v_mov_b32 v181, 0
    v_mov_b32 v182, 0
    v_mov_b32 v183, 0
    v_mov_b32 v184, 0
    v_mov_b32 v185, 0
    v_mov_b32 v186, 0
    v_mov_b32 v187, 0
    v_mov_b32 v188, 0
    v_mov_b32 v189, 0
    v_mov_b32 v190, 0
    v_mov_b32 v191, 0
    v_mov_b32 v192, 0
    v_mov_b32 v193, 0
    v_mov_b32 v194, 0
    v_mov_b32 v195, 0
    v_mov_b32 v196, 0
    v_mov_b32 v197, 0
    v_mov_b32 v198, 0
    v_mov_b32 v199, 0
    v_mov_b32 v200, 0
    v_mov_b32 v201, 0
    v_mov_b32 v202, 0
    v_mov_b32 v203, 0
    v_mov_b32 v204, 0
    v_mov_b32 v205, 0
    v_mov_b32 v206, 0
    v_mov_b32 v207, 0
    v_mov_b32 v208, 0
    v_mov_b32 v209, 0
    v_mov_b32 v210, 0
    v_mov_b32 v211, 0
    v_mov_b32 v212, 0
    v_mov_b32 v213, 0
    v_mov_b32 v214, 0
    v_mov_b32 v215, 0
    v_mov_b32 v216, 0
    v_mov_b32 v217, 0
    v_mov_b32 v218, 0
    v_mov_b32 v219, 0
    v_mov_b32 v220, 0
    v_mov_b32 v221, 0
    v_mov_b32 v222, 0
    v_mov_b32 v223, 0
    s_waitcnt vmcnt(17)
    s_barrier
    ds_read_b128 v[88:91], v10
    ds_read_b64_tr_b16 v[96:97], v11 offset:0
    ds_read_b64_tr_b16 v[98:99], v11 offset:768
    v_xor_b32 v13, 4096, v10
    ds_read_b128 v[92:95], v13
    ds_read_b64_tr_b16 v[100:101], v11 offset:32
    ds_read_b64_tr_b16 v[102:103], v11 offset:800
    ds_read_b64_tr_b16 v[104:105], v11 offset:64
    ds_read_b64_tr_b16 v[106:107], v11 offset:832
    s_mov_b32 s51, 0
    s_cmp_lt_u32 s40, 4
    s_cbranch_scc0 K1_LOOPP
.p2align 6
K1_LOOPA:
    v_add_u32 v12, s58, v23
    s_add_u32 s58, s58, 12352
    s_cmp_ge_u32 s58, 61760
    s_cselect_b32 s58, 0, s58
    v_add_u32 v11, s58, v22
    s_waitcnt vmcnt(14)
    s_barrier
    s_waitcnt lgkmcnt(0)
    v_mfma_f32_32x32x16_bf16 v[128:143], v[96:99], v[88:91], v[128:143]
    v_xor_b32 v13, 32, v10
    ds_read_b128 v[108:111], v13
    ds_read_b64_tr_b16 v[116:117], v12 offset:0
    v_mfma_f32_32x32x16_bf16 v[176:191], v[96:99], v[92:95], v[176:191]
    ds_read_b64_tr_b16 v[118:119], v12 offset:768
    v_xor_b32 v13, 4128, v10
    ds_read_b128 v[112:115], v13
    v_mfma_f32_32x32x16_bf16 v[144:159], v[100:103], v[88:91], v[144:159]
    ds_read_b64_tr_b16 v[120:121], v12 offset:32
    ds_read_b64_tr_b16 v[122:123], v12 offset:800
    s_mov_b32 m0, s55
    s_nop 0
    buffer_load_dwordx4 v72, s[8:11], s52 offen lds
    v_mfma_f32_32x32x16_bf16 v[192:207], v[100:103], v[92:95], v[192:207]
    ds_read_b64_tr_b16 v[124:125], v12 offset:64
    ds_read_b64_tr_b16 v[126:127], v12 offset:832
    s_add_u32 m0, s55, 1024
    s_nop 0
    buffer_load_dwordx4 v73, s[8:11], s52 offen lds
    v_mfma_f32_32x32x16_bf16 v[160:175], v[104:107], v[88:91], v[160:175]
    s_add_u32 m0, s55, 2048
    s_nop 0
    buffer_load_dwordx4 v74, s[8:11], s52 offen lds
    v_mfma_f32_32x32x16_bf16 v[208:223], v[104:107], v[92:95], v[208:223]
    s_add_u32 m0, s55, 3072
    s_nop 0
    buffer_load_dwordx4 v75, s[8:11], s52 offen lds
    s_waitcnt lgkmcnt(0)
    v_mfma_f32_32x32x16_bf16 v[128:143], v[116:119], v[108:111], v[128:143]
    v_xor_b32 v13, 64, v10
    ds_read_b128 v[88:91], v13
    ds_read_b64_tr_b16 v[96:97], v11 offset:0
    v_mfma_f32_32x32x16_bf16 v[176:191], v[116:119], v[112:115], v[176:191]
    ds_read_b64_tr_b16 v[98:99], v11 offset:768
    v_xor_b32 v13, 4160, v10
    ds_read_b128 v[92:95], v13
    v_mfma_f32_32x32x16_bf16 v[144:159], v[120:123], v[108:111], v[144:159]
    ds_read_b64_tr_b16 v[100:101], v11 offset:32
    ds_read_b64_tr_b16 v[102:103], v11 offset:800
    v_mfma_f32_32x32x16_bf16 v[192:207], v[120:123], v[112:115], v[192:207]
    ds_read_b64_tr_b16 v[104:105], v11 offset:64
    ds_read_b64_tr_b16 v[106:107], v11 offset:832
    s_mov_b32 m0, s56
    s_nop 0
    buffer_load_dwordx4 v80, s[12:15], s53 offen lds
    v_mfma_f32_32x32x16_bf16 v[160:175], v[124:127], v[108:111], v[160:175]
    s_add_u32 m0, s56, 1024
    s_nop 0
    buffer_load_dwordx4 v81, s[12:15], s53 offen lds
    v_mfma_f32_32x32x16_bf16 v[208:223], v[124:127], v[112:115], v[208:223]
    s_add_u32 m0, s56, 2048
    s_nop 0
    buffer_load_dwordx4 v82, s[12:15], s53 offen lds
    s_add_u32 s56, s56, 12352
    s_add_u32 s53, s53, s54
    s_cmp_ge_u32 s56, 160064
    s_cselect_b32 s60, 61760, 0
    s_sub_u32 s56, s56, s60
    v_add_u32 v12, s58, v23
    s_add_u32 s58, s58, 12352
    s_cmp_ge_u32 s58, 61760
    s_cselect_b32 s58, 0, s58
    v_add_u32 v11, s58, v22
    s_waitcnt vmcnt(10)
    s_barrier
    s_waitcnt lgkmcnt(0)
    v_mfma_f32_32x32x16_bf16 v[128:143], v[96:99], v[88:91], v[128:143]
    v_xor_b32 v13, 96, v10
    ds_read_b128 v[108:111], v13
    ds_read_b64_tr_b16 v[116:117], v12 offset:0
    v_mfma_f32_32x32x16_bf16 v[176:191], v[96:99], v[92:95], v[176:191]
    ds_read_b64_tr_b16 v[118:119], v12 offset:768
    v_xor_b32 v13, 4192, v10
    ds_read_b128 v[112:115], v13
    v_mfma_f32_32x32x16_bf16 v[144:159], v[100:103], v[88:91], v[144:159]
    ds_read_b64_tr_b16 v[120:121], v12 offset:32
    ds_read_b64_tr_b16 v[122:123], v12 offset:800
    s_add_u32 m0, s55, 4096
    s_nop 0
    buffer_load_dwordx4 v76, s[8:11], s52 offen lds
    v_mfma_f32_32x32x16_bf16 v[192:207], v[100:103], v[92:95], v[192:207]
    ds_read_b64_tr_b16 v[124:125], v12 offset:64
    ds_read_b64_tr_b16 v[126:127], v12 offset:832
    s_add_u32 s57, s57, 32768
    s_cmp_ge_u32 s57, 98304
    s_cselect_b32 s57, 0, s57
    v_add_u32 v10, s57, v21
    s_add_u32 m0, s55, 5120
    s_nop 0
    buffer_load_dwordx4 v77, s[8:11], s52 offen lds
    v_mfma_f32_32x32x16_bf16 v[160:175], v[104:107], v[88:91], v[160:175]
    s_add_u32 m0, s55, 6144
    s_nop 0
    buffer_load_dwordx4 v78, s[8:11], s52 offen lds
    v_mfma_f32_32x32x16_bf16 v[208:223], v[104:107], v[92:95], v[208:223]
    s_add_u32 m0, s55, 7168
    s_nop 0
    buffer_load_dwordx4 v79, s[8:11], s52 offen lds
    s_add_u32 s55, s55, 32768
    s_add_u32 s52, s52, 128
    s_cmp_ge_u32 s55, 98304
    s_cselect_b32 s60, 98304, 0
    s_sub_u32 s55, s55, s60
    s_waitcnt lgkmcnt(0)
    v_mfma_f32_32x32x16_bf16 v[128:143], v[116:119], v[108:111], v[128:143]
    ds_read_b128 v[88:91], v10
    ds_read_b64_tr_b16 v[96:97], v11 offset:0
    v_mfma_f32_32x32x16_bf16 v[176:191], v[116:119], v[112:115], v[176:191]
    ds_read_b64_tr_b16 v[98:99], v11 offset:768
    v_xor_b32 v13, 4096, v10
    ds_read_b128 v[92:95], v13
    v_mfma_f32_32x32x16_bf16 v[144:159], v[120:123], v[108:111], v[144:159]
    ds_read_b64_tr_b16 v[100:101], v11 offset:32
    ds_read_b64_tr_b16 v[102:103], v11 offset:800
    v_mfma_f32_32x32x16_bf16 v[192:207], v[120:123], v[112:115], v[192:207]
    ds_read_b64_tr_b16 v[104:105], v11 offset:64
    ds_read_b64_tr_b16 v[106:107], v11 offset:832
    s_mov_b32 m0, s56
    s_nop 0
    buffer_load_dwordx4 v80, s[12:15], s53 offen lds
    v_mfma_f32_32x32x16_bf16 v[160:175], v[124:127], v[108:111], v[160:175]
    s_add_u32 m0, s56, 1024
    s_nop 0
    buffer_load_dwordx4 v81, s[12:15], s53 offen lds
    v_mfma_f32_32x32x16_bf16 v[208:223], v[124:127], v[112:115], v[208:223]
    s_add_u32 m0, s56, 2048
    s_nop 0
    buffer_load_dwordx4 v82, s[12:15], s53 offen lds
    s_add_u32 s56, s56, 12352
    s_add_u32 s53, s53, s54
    s_cmp_ge_u32 s56, 160064
    s_cselect_b32 s60, 61760, 0
    s_sub_u32 s56, s56, s60
    s_add_u32 s51, s51, 1
    s_cmp_lt_u32 s51, 8
    s_cbranch_scc1 K1_LOOPA
    s_branch K1_LOOPB
.p2align 6
K1_LOOPP:
    v_add_u32 v12, s58, v23
    s_add_u32 s58, s58, 12352
    s_cmp_ge_u32 s58, 61760
    s_cselect_b32 s58, 0, s58
    v_add_u32 v11, s58, v22
    s_barrier
    s_waitcnt lgkmcnt(0)
    v_mfma_f32_32x32x16_bf16 v[128:143], v[96:99], v[88:91], v[128:143]
    v_xor_b32 v13, 32, v10
    ds_read_b128 v[108:111], v13
    ds_read_b64_tr_b16 v[116:117], v12 offset:0
    v_mfma_f32_32x32x16_bf16 v[176:191], v[96:99], v[92:95], v[176:191]
    ds_read_b64_tr_b16 v[118:119], v12 offset:768
    v_xor_b32 v13, 4128, v10
    ds_read_b128 v[112:115], v13
    v_mfma_f32_32x32x16_bf16 v[144:159], v[100:103], v[88:91], v[144:159]
    ds_read_b64_tr_b16 v[120:121], v12 offset:32
    ds_read_b64_tr_b16 v[122:123], v12 offset:800
    v_mfma_f32_32x32x16_bf16 v[192:207], v[100:103], v[92:95], v[192:207]
    ds_read_b64_tr_b16 v[124:125], v12 offset:64
    ds_read_b64_tr_b16 v[126:127], v12 offset:832
    v_mfma_f32_32x32x16_bf16 v[160:175], v[104:107], v[88:91], v[160:175]
    v_mfma_f32_32x32x16_bf16 v[208:223], v[104:107], v[92:95], v[208:223]
    s_waitcnt lgkmcnt(0)
    v_mfma_f32_32x32x16_bf16 v[128:143], v[116:119], v[108:111], v[128:143]
    v_xor_b32 v13, 64, v10
    ds_read_b128 v[88:91], v13
    ds_read_b64_tr_b16 v[96:97], v11 offset:0
    v_mfma_f32_32x32x16_bf16 v[176:191], v[116:119], v[112:115], v[176:191]
    ds_read_b64_tr_b16 v[98:99], v11 offset:768
    v_xor_b32 v13, 4160, v10
    ds_read_b128 v[92:95], v13
    v_mfma_f32_32x32x16_bf16 v[144:159], v[120:123], v[108:111], v[144:159]
    ds_read_b64_tr_b16 v[100:101], v11 offset:32
    ds_read_b64_tr_b16 v[102:103], v11 offset:800
    v_mfma_f32_32x32x16_bf16 v[192:207], v[120:123], v[112:115], v[192:207]
    ds_read_b64_tr_b16 v[104:105], v11 offset:64
    ds_read_b64_tr_b16 v[106:107], v11 offset:832
    v_mfma_f32_32x32x16_bf16 v[160:175], v[124:127], v[108:111], v[160:175]
    v_mfma_f32_32x32x16_bf16 v[208:223], v[124:127], v[112:115], v[208:223]
    v_add_u32 v12, s58, v23
    s_add_u32 s58, s58, 12352
    s_cmp_ge_u32 s58, 61760
    s_cselect_b32 s58, 0, s58
    v_add_u32 v11, s58, v22
    s_barrier
    s_waitcnt lgkmcnt(0)
    v_mfma_f32_32x32x16_bf16 v[128:143], v[96:99], v[88:91], v[128:143]
    v_xor_b32 v13, 96, v10
    ds_read_b128 v[108:111], v13
    ds_read_b64_tr_b16 v[116:117], v12 offset:0
    v_mfma_f32_32x32x16_bf16 v[176:191], v[96:99], v[92:95], v[176:191]
    ds_read_b64_tr_b16 v[118:119], v12 offset:768
    v_xor_b32 v13, 4192, v10
    ds_read_b128 v[112:115], v13
    v_mfma_f32_32x32x16_bf16 v[144:159], v[100:103], v[88:91], v[144:159]
    ds_read_b64_tr_b16 v[120:121], v12 offset:32
    ds_read_b64_tr_b16 v[122:123], v12 offset:800
    v_mfma_f32_32x32x16_bf16 v[192:207], v[100:103], v[92:95], v[192:207]
    ds_read_b64_tr_b16 v[124:125], v12 offset:64
    ds_read_b64_tr_b16 v[126:127], v12 offset:832
    s_add_u32 s57, s57, 32768
    s_cmp_ge_u32 s57, 98304
    s_cselect_b32 s57, 0, s57
    v_add_u32 v10, s57, v21
    v_mfma_f32_32x32x16_bf16 v[160:175], v[104:107], v[88:91], v[160:175]
    v_mfma_f32_32x32x16_bf16 v[208:223], v[104:107], v[92:95], v[208:223]
    s_waitcnt lgkmcnt(0)
    v_mfma_f32_32x32x16_bf16 v[128:143], v[116:119], v[108:111], v[128:143]
    ds_read_b128 v[88:91], v10
    ds_read_b64_tr_b16 v[96:97], v11 offset:0
    v_mfma_f32_32x32x16_bf16 v[176:191], v[116:119], v[112:115], v[176:191]
    ds_read_b64_tr_b16 v[98:99], v11 offset:768
    v_xor_b32 v13, 4096, v10
    ds_read_b128 v[92:95], v13
    v_mfma_f32_32x32x16_bf16 v[144:159], v[120:123], v[108:111], v[144:159]
    ds_read_b64_tr_b16 v[100:101], v11 offset:32
    ds_read_b64_tr_b16 v[102:103], v11 offset:800
    v_mfma_f32_32x32x16_bf16 v[192:207], v[120:123], v[112:115], v[192:207]
    ds_read_b64_tr_b16 v[104:105], v11 offset:64
    ds_read_b64_tr_b16 v[106:107], v11 offset:832
    v_mfma_f32_32x32x16_bf16 v[160:175], v[124:127], v[108:111], v[160:175]
    v_mfma_f32_32x32x16_bf16 v[208:223], v[124:127], v[112:115], v[208:223]
    s_cmp_eq_u32 s51, 1
    s_cbranch_scc0 K1_PH1
    s_lshl_b32 s60, s40, 8
    s_add_u32 s60, s60, 159040
    s_mov_b32 s66, 0x3f803f80
    v_mov_b32 v14, 0
    v_mov_b32 v15, 0
    v_mov_b32 v16, 0
    v_mov_b32 v17, 0
    s_waitcnt vmcnt(0)
    v_lshlrev_b32 v64, 16, v24
    v_and_b32 v65, 0xffff0000, v24
    v_lshlrev_b32 v66, 16, v25
    v_and_b32 v67, 0xffff0000, v25
    v_lshlrev_b32 v68, 16, v26
    v_and_b32 v69, 0xffff0000, v26
    v_lshlrev_b32 v70, 16, v27
    v_and_b32 v71, 0xffff0000, v27
    v_lshlrev_b32 v19, 16, v28
    v_and_b32 v28, 0xffff0000, v28
    v_add_f32 v64, v64, v19
    v_add_f32 v65, v65, v28
    v_lshlrev_b32 v19, 16, v29
    v_and_b32 v29, 0xffff0000, v29
    v_add_f32 v66, v66, v19
    v_add_f32 v67, v67, v29
    v_lshlrev_b32 v19, 16, v30
    v_and_b32 v30, 0xffff0000, v30
    v_add_f32 v68, v68, v19
    v_add_f32 v69, v69, v30
    v_lshlrev_b32 v19, 16, v31
    v_and_b32 v31, 0xffff0000, v31
    v_add_f32 v70, v70, v19
    v_add_f32 v71, v71, v31
    v_lshlrev_b32 v19, 16, v32
    v_and_b32 v32, 0xffff0000, v32
    v_add_f32 v64, v64, v19
    v_add_f32 v65, v65, v32
    v_lshlrev_b32 v19, 16, v33
    v_and_b32 v33, 0xffff0000, v33
    v_add_f32 v66, v66, v19
    v_add_f32 v67, v67, v33
    v_lshlrev_b32 v19, 16, v34
    v_and_b32 v34, 0xffff0000, v34
    v_add_f32 v68, v68, v19
    v_add_f32 v69, v69, v34
    v_lshlrev_b32 v19, 16, v35
    v_and_b32 v35, 0xffff0000, v35
    v_add_f32 v70, v70, v19
    v_add_f32 v71, v71, v35
    v_lshlrev_b32 v19, 16, v36
    v_and_b32 v36, 0xffff0000, v36
    v_add_f32 v64, v64, v19
    v_add_f32 v65, v65, v36
    v_lshlrev_b32 v19, 16, v37
    v_and_b32 v37, 0xffff0000, v37
    v_add_f32 v66, v66, v19
    v_add_f32 v67, v67, v37
    v_lshlrev_b32 v19, 16, v38
    v_and_b32 v38, 0xffff0000, v38
    v_add_f32 v68, v68, v19
    v_add_f32 v69, v69, v38
    v_lshlrev_b32 v19, 16, v39
    v_and_b32 v39, 0xffff0000, v39
    v_add_f32 v70, v70, v19
    v_add_f32 v71, v71, v39
    v_lshlrev_b32 v19, 16, v40
    v_and_b32 v40, 0xffff0000, v40
    v_add_f32 v64, v64, v19
    v_add_f32 v65, v65, v40
    v_lshlrev_b32 v19, 16, v41
    v_and_b32 v41, 0xffff0000, v41
    v_add_f32 v66, v66, v19
    v_add_f32 v67, v67, v41
    v_lshlrev_b32 v19, 16, v42
    v_and_b32 v42, 0xffff0000, v42
    v_add_f32 v68, v68, v19
    v_add_f32 v69, v69, v42
    v_lshlrev_b32 v19, 16, v43
    v_and_b32 v43, 0xffff0000, v43
    v_add_f32 v70, v70, v19
    v_add_f32 v71, v71, v43
    v_lshlrev_b32 v19, 16, v44
    v_and_b32 v44, 0xffff0000, v44
    v_add_f32 v64, v64, v19
    v_add_f32 v65, v65, v44
    v_lshlrev_b32 v19, 16, v45
    v_and_b32 v45, 0xffff0000, v45
    v_add_f32 v66, v66, v19
    v_add_f32 v67, v67, v45
    v_lshlrev_b32 v19, 16, v46
    v_and_b32 v46, 0xffff0000, v46
    v_add_f32 v68, v68, v19
    v_add_f32 v69, v69, v46
    v_lshlrev_b32 v19, 16, v47
    v_and_b32 v47, 0xffff0000, v47
    v_add_f32 v70, v70, v19
    v_add_f32 v71, v71, v47
    v_lshlrev_b32 v19, 16, v48
    v_and_b32 v48, 0xffff0000, v48
    v_add_f32 v64, v64, v19
    v_add_f32 v65, v65, v48
    v_lshlrev_b32 v19, 16, v49
    v_and_b32 v49, 0xffff0000, v49
    v_add_f32 v66, v66, v19
    v_add_f32 v67, v67, v49
    v_lshlrev_b32 v19, 16, v50
    v_and_b32 v50, 0xffff0000, v50
    v_add_f32 v68, v68, v19
    v_add_f32 v69, v69, v50
    v_lshlrev_b32 v19, 16, v51
    v_and_b32 v51, 0xffff0000, v51
    v_add_f32 v70, v70, v19
    v_add_f32 v71, v71, v51
    v_and_b32 v19, 7, v1
    v_lshl_add_u32 v18, v19, 5, s60
    v_lshrrev_b32 v19, 4, v1
    v_lshl_add_u32 v18, v19, 3, v18
    v_permlane32_swap_b32 v64, v68
    v_permlane32_swap_b32 v65, v69
    v_permlane32_swap_b32 v66, v70
    v_permlane32_swap_b32 v67, v71
    s_nop 1
    v_add_f32 v64, v64, v68
    v_add_f32 v65, v65, v69
    v_add_f32 v66, v66, v70
    v_add_f32 v67, v67, v71
    s_nop 1
    v_permlane16_swap_b32 v64, v66
    v_permlane16_swap_b32 v65, v67
    s_nop 1
    v_add_f32 v64, v64, v66
    v_add_f32 v65, v65, v67
    s_nop 1
    v_add_f32_dpp v64, v64, v64 row_ror:8 row_mask:0xf bank_mask:0xf
    v_add_f32_dpp v65, v65, v65 row_ror:8 row_mask:0xf bank_mask:0xf
    ds_write_b64 v18, v[64:65]
    v_dot2c_f32_bf16 v14, s66, v52
    v_dot2c_f32_bf16 v16, v52, v52
    v_dot2c_f32_bf16 v15, s66, v53
    v_dot2c_f32_bf16 v17, v53, v53
    v_dot2c_f32_bf16 v14, s66, v54
    v_dot2c_f32_bf16 v16, v54, v54
    v_dot2c_f32_bf16 v15, s66, v55
    v_dot2c_f32_bf16 v17, v55, v55
    v_dot2c_f32_bf16 v14, s66, v56
    v_dot2c_f32_bf16 v16, v56, v56
    v_dot2c_f32_bf16 v15, s66, v57
    v_dot2c_f32_bf16 v17, v57, v57
    v_dot2c_f32_bf16 v14, s66, v58
    v_dot2c_f32_bf16 v16, v58, v58
    v_dot2c_f32_bf16 v15, s66, v59
    v_dot2c_f32_bf16 v17, v59, v59
    v_dot2c_f32_bf16 v14, s66, v60
    v_dot2c_f32_bf16 v16, v60, v60
    v_dot2c_f32_bf16 v15, s66, v61
    v_dot2c_f32_bf16 v17, v61, v61
    v_dot2c_f32_bf16 v14, s66, v62
    v_dot2c_f32_bf16 v16, v62, v62
    v_dot2c_f32_bf16 v15, s66, v63
    v_dot2c_f32_bf16 v17, v63, v63
    s_nop 2
    v_add_f32 v14, v14, v15
    v_add_f32 v16, v16, v17
    s_nop 1
    v_add_f32_dpp v14, v14, v14 quad_perm:[1,0,3,2] row_mask:0xf bank_mask:0xf
    v_add_f32_dpp v16, v16, v16 quad_perm:[1,0,3,2] row_mask:0xf bank_mask:0xf
    s_nop 1
    v_add_f32_dpp v14, v14, v14 quad_perm:[2,3,0,1] row_mask:0xf bank_mask:0xf
    v_add_f32_dpp v16, v16, v16 quad_perm:[2,3,0,1] row_mask:0xf bank_mask:0xf
    s_nop 1
    v_add_f32_dpp v14, v14, v14 row_half_mirror row_mask:0xf bank_mask:0xf
    v_add_f32_dpp v16, v16, v16 row_half_mirror row_mask:0xf bank_mask:0xf
    s_nop 1
    v_add_f32_dpp v14, v14, v14 row_mirror row_mask:0xf bank_mask:0xf
    v_add_f32_dpp v16, v16, v16 row_mirror row_mask:0xf bank_mask:0xf
    v_mov_b32 v15, v14
    v_mov_b32 v17, v16
    s_nop 1
    v_permlane16_swap_b32 v14, v15
    v_permlane16_swap_b32 v16, v17
    s_nop 1
    v_add_f32 v14, v14, v15
    v_add_f32 v16, v16, v17
    v_mul_f32 v14, 0x3acccccd, v14
    v_mul_f32 v16, 0x3acccccd, v16
    v_fma_f32 v16, -v14, v14, v16
    v_max_f32 v16, 0, v16
    v_cvt_pk_bf16_f32 v14, v14, v14
    v_cvt_pk_bf16_f32 v16, v16, v16
    v_and_b32 v16, 0xffff0000, v16
    v_add_f32 v16, 0x3727c5ac, v16
    v_cvt_pk_bf16_f32 v16, v16, v16
    v_and_b32 v16, 0xffff0000, v16
    v_sqrt_f32 v16, v16
    s_lshl_b32 s60, s40, 4
    s_add_u32 s60, s60, 161024
    v_cvt_pk_bf16_f32 v16, v16, v16
    v_and_b32 v15, 0xffff0000, v16
    v_lshl_add_u32 v18, v3, 3, s60
    ds_write_b64 v18, v[14:15]
    s_waitcnt lgkmcnt(0)
K1_PH1:
    s_cmp_eq_u32 s40, 4
    s_cbranch_scc0 K1_PH3
    s_cmp_eq_u32 s51, 2
    s_cbranch_scc0 K1_PH2
    v_lshlrev_b32 v24, 2, v1
    v_add_u32 v25, 160064, v24
    ds_read_b32 v26, v25 offset:0
    ds_read_b32 v27, v25 offset:256
    ds_read_b32 v28, v25 offset:512
    ds_read_b32 v29, v25 offset:768
    ds_read_b32 v30, v25 offset:1024
    v_lshrrev_b32 v31, 4, v1
    v_min_u32 v31, 1, v31
    v_lshl_add_u32 v31, v31, 30, v24
    s_lshl_b32 s60, s2, 6
    s_add_u32 s60, s60, 13582848
    s_waitcnt lgkmcnt(0)
    v_add_f32 v26, v26, v27
    v_add_f32 v28, v28, v29
    v_add_f32 v26, v26, v28
    buffer_store_dword v26, v24, s[20:23], s73 offen sc1
    buffer_store_dword v30, v31, s[20:23], s60 offen sc1
    s_lshl_b32 s60, s2, 7
    s_add_u32 s60, s60, 13599232
    v_mov_b32 v27, 0
    buffer_store_dword v27, v31, s[20:23], s60 offen sc1
K1_PH2:
    s_cmp_eq_u32 s51, 4
    s_cbranch_scc0 K1_PH3
    s_and_b32 s61, s2, 7
    s_mov_b32 s76, s4
    s_and_b32 s77, s5, 0xffff
    s_mov_b32 s78, 256
    s_mov_b32 s79, 0x00020000
    s_lshl_b32 s60, s61, 2
    v_mov_b32 v32, 0
    v_mov_b32 v33, 1
    s_waitcnt vmcnt(0)
    s_mov_b64 exec, 1
    buffer_atomic_add v33, v32, s[76:79], s60 offen sc1
    s_mov_b64 exec, -1
K1_PH3:
    s_add_u32 s51, s51, 1
    s_cmp_lt_u32 s51, 8
    s_cbranch_scc1 K1_LOOPP
K1_LOOPB:
    v_add_u32 v12, s58, v23
    s_add_u32 s58, s58, 12352
    s_cmp_ge_u32 s58, 61760
    s_cselect_b32 s58, 0, s58
    v_add_u32 v11, s58, v22
    s_mov_b32 s76, s4
    s_and_b32 s77, s5, 0xffff
    s_mov_b32 s78, 256
    s_mov_b32 s79, 0x00020000
    v_and_b32 v34, 7, v1
    v_lshlrev_b32 v34, 2, v34
    buffer_load_dword v35, v34, s[76:79], 0 offen sc1
    s_lshl_b32 s60, s40, 5
    v_add_u32 v36, s60, v2
    v_xor_b32 v37, 32, v36
    v_add_u32 v36, s46, v36
    v_med3_i32 v36, v36, 0, s74
    v_lshlrev_b32 v36, 3, v36
    v_add_u32 v37, s46, v37
    v_med3_i32 v37, v37, 0, s74
    v_lshlrev_b32 v37, 3, v37
    v_and_b32 v38, 3, v2
    v_bfe_u32 v39, v2, 2, 1
    v_lshl_add_u32 v38, v39, 3, v38
    v_bfe_u32 v39, v2, 3, 1
    v_lshl_add_u32 v38, v39, 2, v38
    s_mul_i32 s60, s42, 48
    v_add_u32 v38, s60, v38
    v_lshrrev_b32 v39, 4, v2
    s_cmp_eq_u32 s44, 0
    s_cselect_b32 s60, 96, 60
    s_mul_i32 s60, s60, s45
    s_cselect_b32 s61, 0, 3456
    s_add_u32 s60, s60, s61
    s_cmp_eq_u32 s44, 0
    s_movk_i32 s61, 672
    s_cselect_b32 s61, 1728, s61
    v_mul_u32_u24 v40, s61, v39
    v_add_u32 v40, s60, v40
    v_lshrrev_b32 v39, v39, 64
    s_lshr_b32 s61, s48, 1
    v_mov_b32 v41, s61
    v_mul_u32_u24 v42, 11008, v3
    v_add_u32 v43, 0, v38
    v_cmp_le_u32 vcc, v39, v43
    v_add_u32 v43, v43, v40
    s_nop 0
    v_cndmask_b32 v44, 0, v41, vcc
    v_add_u32 v43, v43, v44
    v_lshlrev_b32 v48, 2, v43
    v_add_lshl_u32 v52, v43, v42, 2
    v_add_u32 v43, 16, v38
    v_cmp_le_u32 vcc, v39, v43
    v_add_u32 v43, v43, v40
    s_nop 0
    v_cndmask_b32 v44, 0, v41, vcc
    v_add_u32 v43, v43, v44
    v_lshlrev_b32 v49, 2, v43
    v_add_lshl_u32 v53, v43, v42, 2
    v_add_u32 v43, 32, v38
    v_cmp_le_u32 vcc, v39, v43
    v_add_u32 v43, v43, v40
    s_nop 0
    v_cndmask_b32 v44, 0, v41, vcc
    v_add_u32 v43, v43, v44
    v_lshlrev_b32 v50, 2, v43
    v_add_lshl_u32 v54, v43, v42, 2
    s_waitcnt vmcnt(15)
    s_barrier
    s_waitcnt lgkmcnt(0)
    v_mfma_f32_32x32x16_bf16 v[128:143], v[96:99], v[88:91], v[128:143]
    v_xor_b32 v13, 32, v10
    ds_read_b128 v[108:111], v13
    ds_read_b64_tr_b16 v[116:117], v12 offset:0
    v_mfma_f32_32x32x16_bf16 v[176:191], v[96:99], v[92:95], v[176:191]
    ds_read_b64_tr_b16 v[118:119], v12 offset:768
    v_xor_b32 v13, 4128, v10
    ds_read_b128 v[112:115], v13
    v_mfma_f32_32x32x16_bf16 v[144:159], v[100:103], v[88:91], v[144:159]
    ds_read_b64_tr_b16 v[120:121], v12 offset:32
    ds_read_b64_tr_b16 v[122:123], v12 offset:800
    v_mfma_f32_32x32x16_bf16 v[192:207], v[100:103], v[92:95], v[192:207]
    ds_read_b64_tr_b16 v[124:125], v12 offset:64
    ds_read_b64_tr_b16 v[126:127], v12 offset:832
    v_mfma_f32_32x32x16_bf16 v[160:175], v[104:107], v[88:91], v[160:175]
    v_mfma_f32_32x32x16_bf16 v[208:223], v[104:107], v[92:95], v[208:223]
    s_waitcnt lgkmcnt(0)
    v_mfma_f32_32x32x16_bf16 v[128:143], v[116:119], v[108:111], v[128:143]
    v_xor_b32 v13, 64, v10
    ds_read_b128 v[88:91], v13
    ds_read_b64_tr_b16 v[96:97], v11 offset:0
    v_mfma_f32_32x32x16_bf16 v[176:191], v[116:119], v[112:115], v[176:191]
    ds_read_b64_tr_b16 v[98:99], v11 offset:768
    v_xor_b32 v13, 4160, v10
    ds_read_b128 v[92:95], v13
    v_mfma_f32_32x32x16_bf16 v[144:159], v[120:123], v[108:111], v[144:159]
    ds_read_b64_tr_b16 v[100:101], v11 offset:32
    ds_read_b64_tr_b16 v[102:103], v11 offset:800
    v_mfma_f32_32x32x16_bf16 v[192:207], v[120:123], v[112:115], v[192:207]
    ds_read_b64_tr_b16 v[104:105], v11 offset:64
    ds_read_b64_tr_b16 v[106:107], v11 offset:832
    v_mfma_f32_32x32x16_bf16 v[160:175], v[124:127], v[108:111], v[160:175]
    v_mfma_f32_32x32x16_bf16 v[208:223], v[124:127], v[112:115], v[208:223]
    v_add_u32 v12, s58, v23
    s_add_u32 s58, s58, 12352
    s_cmp_ge_u32 s58, 61760
    s_cselect_b32 s58, 0, s58
    v_add_u32 v11, s58, v22
    s_waitcnt vmcnt(0)
    s_mov_b32 s61, 0
K1_POLL:
    v_cmp_ne_u32 vcc, 32, v35
    s_nop 4
    s_cbranch_vccz K1_POLLOK
    s_sleep 8
    buffer_load_dword v35, v34, s[76:79], 0 offen sc1
    s_add_u32 s61, s61, 1
    s_cmp_lt_u32 s61, 0x4000
    s_waitcnt vmcnt(0)
    s_cbranch_scc1 K1_POLL
K1_POLLOK:
    s_mov_b32 s60, 13582848
    s_mov_b32 s61, 13516800
    s_mov_b32 s62, 13538816
    buffer_load_dwordx2 v[24:25], v36, s[20:23], s60 offen sc1
    buffer_load_dwordx2 v[26:27], v37, s[20:23], s60 offen sc1
    buffer_load_dword v28, v52, s[20:23], s61 offen sc1
    buffer_load_dword v31, v48, s[20:23], s62 offen sc1
    buffer_load_dword v29, v53, s[20:23], s61 offen sc1
    buffer_load_dword v32, v49, s[20:23], s62 offen sc1
    buffer_load_dword v30, v54, s[20:23], s61 offen sc1
    buffer_load_dword v33, v50, s[20:23], s62 offen sc1
    s_barrier
    s_waitcnt lgkmcnt(0)
    v_mfma_f32_32x32x16_bf16 v[128:143], v[96:99], v[88:91], v[128:143]
    v_xor_b32 v13, 96, v10
    ds_read_b128 v[108:111], v13
    ds_read_b64_tr_b16 v[116:117], v12 offset:0
    v_mfma_f32_32x32x16_bf16 v[176:191], v[96:99], v[92:95], v[176:191]
    ds_read_b64_tr_b16 v[118:119], v12 offset:768
    v_xor_b32 v13, 4192, v10
    ds_read_b128 v[112:115], v13
    v_mfma_f32_32x32x16_bf16 v[144:159], v[100:103], v[88:91], v[144:159]
    ds_read_b64_tr_b16 v[120:121], v12 offset:32
    ds_read_b64_tr_b16 v[122:123], v12 offset:800
    v_mfma_f32_32x32x16_bf16 v[192:207], v[100:103], v[92:95], v[192:207]
    ds_read_b64_tr_b16 v[124:125], v12 offset:64
    ds_read_b64_tr_b16 v[126:127], v12 offset:832
    s_add_u32 s57, s57, 32768
    s_cmp_ge_u32 s57, 98304
    s_cselect_b32 s57, 0, s57
    v_add_u32 v10, s57, v21
    v_mfma_f32_32x32x16_bf16 v[160:175], v[104:107], v[88:91], v[160:175]
    v_mfma_f32_32x32x16_bf16 v[208:223], v[104:107], v[92:95], v[208:223]
    s_waitcnt lgkmcnt(0)
    v_mfma_f32_32x32x16_bf16 v[128:143], v[116:119], v[108:111], v[128:143]
    ds_read_b128 v[88:91], v10
    ds_read_b64_tr_b16 v[96:97], v11 offset:0
    v_mfma_f32_32x32x16_bf16 v[176:191], v[116:119], v[112:115], v[176:191]
    ds_read_b64_tr_b16 v[98:99], v11 offset:768
    v_xor_b32 v13, 4096, v10
    ds_read_b128 v[92:95], v13
    v_mfma_f32_32x32x16_bf16 v[144:159], v[120:123], v[108:111], v[144:159]
    ds_read_b64_tr_b16 v[100:101], v11 offset:32
    ds_read_b64_tr_b16 v[102:103], v11 offset:800
    v_mfma_f32_32x32x16_bf16 v[192:207], v[120:123], v[112:115], v[192:207]
    ds_read_b64_tr_b16 v[104:105], v11 offset:64
    ds_read_b64_tr_b16 v[106:107], v11 offset:832
    v_mfma_f32_32x32x16_bf16 v[160:175], v[124:127], v[108:111], v[160:175]
    v_mfma_f32_32x32x16_bf16 v[208:223], v[124:127], v[112:115], v[208:223]
K1_LOOPC:
    v_add_u32 v12, s58, v23
    s_add_u32 s58, s58, 12352
    s_cmp_ge_u32 s58, 61760
    s_cselect_b32 s58, 0, s58
    v_add_u32 v11, s58, v22
    s_barrier
    s_waitcnt lgkmcnt(0)
    v_mfma_f32_32x32x16_bf16 v[128:143], v[96:99], v[88:91], v[128:143]
    v_xor_b32 v13, 32, v10
    ds_read_b128 v[108:111], v13
    ds_read_b64_tr_b16 v[116:117], v12 offset:0
    v_mfma_f32_32x32x16_bf16 v[176:191], v[96:99], v[92:95], v[176:191]
    ds_read_b64_tr_b16 v[118:119], v12 offset:768
    v_xor_b32 v13, 4128, v10
    ds_read_b128 v[112:115], v13
    v_mfma_f32_32x32x16_bf16 v[144:159], v[100:103], v[88:91], v[144:159]
    ds_read_b64_tr_b16 v[120:121], v12 offset:32
    ds_read_b64_tr_b16 v[122:123], v12 offset:800
    v_mfma_f32_32x32x16_bf16 v[192:207], v[100:103], v[92:95], v[192:207]
    ds_read_b64_tr_b16 v[124:125], v12 offset:64
    ds_read_b64_tr_b16 v[126:127], v12 offset:832
    v_mfma_f32_32x32x16_bf16 v[160:175], v[104:107], v[88:91], v[160:175]
    v_mfma_f32_32x32x16_bf16 v[208:223], v[104:107], v[92:95], v[208:223]
    s_waitcnt lgkmcnt(0)
    v_mfma_f32_32x32x16_bf16 v[128:143], v[116:119], v[108:111], v[128:143]
    v_xor_b32 v13, 64, v10
    ds_read_b128 v[88:91], v13
    ds_read_b64_tr_b16 v[96:97], v11 offset:0
    v_mfma_f32_32x32x16_bf16 v[176:191], v[116:119], v[112:115], v[176:191]
    ds_read_b64_tr_b16 v[98:99], v11 offset:768
    v_xor_b32 v13, 4160, v10
    ds_read_b128 v[92:95], v13
    v_mfma_f32_32x32x16_bf16 v[144:159], v[120:123], v[108:111], v[144:159]
    ds_read_b64_tr_b16 v[100:101], v11 offset:32
    ds_read_b64_tr_b16 v[102:103], v11 offset:800
    v_mfma_f32_32x32x16_bf16 v[192:207], v[120:123], v[112:115], v[192:207]
    ds_read_b64_tr_b16 v[104:105], v11 offset:64
    ds_read_b64_tr_b16 v[106:107], v11 offset:832
    v_mfma_f32_32x32x16_bf16 v[160:175], v[124:127], v[108:111], v[160:175]
    v_mfma_f32_32x32x16_bf16 v[208:223], v[124:127], v[112:115], v[208:223]
    v_add_u32 v12, s58, v23
    s_add_u32 s58, s58, 12352
    s_cmp_ge_u32 s58, 61760
    s_cselect_b32 s58, 0, s58
    v_add_u32 v11, s58, v22
    s_barrier
    s_waitcnt lgkmcnt(0)
    v_mfma_f32_32x32x16_bf16 v[128:143], v[96:99], v[88:91], v[128:143]
    v_xor_b32 v13, 96, v10
    ds_read_b128 v[108:111], v13
    ds_read_b64_tr_b16 v[116:117], v12 offset:0
    v_mfma_f32_32x32x16_bf16 v[176:191], v[96:99], v[92:95], v[176:191]
    ds_read_b64_tr_b16 v[118:119], v12 offset:768
    v_xor_b32 v13, 4192, v10
    ds_read_b128 v[112:115], v13
    v_mfma_f32_32x32x16_bf16 v[144:159], v[100:103], v[88:91], v[144:159]
    ds_read_b64_tr_b16 v[120:121], v12 offset:32
    ds_read_b64_tr_b16 v[122:123], v12 offset:800
    v_mfma_f32_32x32x16_bf16 v[192:207], v[100:103], v[92:95], v[192:207]
    ds_read_b64_tr_b16 v[124:125], v12 offset:64
    ds_read_b64_tr_b16 v[126:127], v12 offset:832
    s_add_u32 s57, s57, 32768
    s_cmp_ge_u32 s57, 98304
    s_cselect_b32 s57, 0, s57
    v_add_u32 v10, s57, v21
    v_mfma_f32_32x32x16_bf16 v[160:175], v[104:107], v[88:91], v[160:175]
    v_mfma_f32_32x32x16_bf16 v[208:223], v[104:107], v[92:95], v[208:223]
    s_waitcnt lgkmcnt(0)
    v_mfma_f32_32x32x16_bf16 v[128:143], v[116:119], v[108:111], v[128:143]
    ds_read_b128 v[88:91], v10
    ds_read_b64_tr_b16 v[96:97], v11 offset:0
    v_mfma_f32_32x32x16_bf16 v[176:191], v[116:119], v[112:115], v[176:191]
    ds_read_b64_tr_b16 v[98:99], v11 offset:768
    v_xor_b32 v13, 4096, v10
    ds_read_b128 v[92:95], v13
    v_mfma_f32_32x32x16_bf16 v[144:159], v[120:123], v[108:111], v[144:159]
    ds_read_b64_tr_b16 v[100:101], v11 offset:32
    ds_read_b64_tr_b16 v[102:103], v11 offset:800
    v_mfma_f32_32x32x16_bf16 v[192:207], v[120:123], v[112:115], v[192:207]
    ds_read_b64_tr_b16 v[104:105], v11 offset:64
    ds_read_b64_tr_b16 v[106:107], v11 offset:832
    v_mfma_f32_32x32x16_bf16 v[160:175], v[124:127], v[108:111], v[160:175]
    v_mfma_f32_32x32x16_bf16 v[208:223], v[124:127], v[112:115], v[208:223]
    v_cmp_eq_u32 vcc, 0, v3
    s_mov_b32 s61, 0xffff
    s_waitcnt vmcnt(0) lgkmcnt(0)
    v_mov_b32 v90, 0
    v_mov_b32 v91, 0
    v_mov_b32 v94, 0
    v_mov_b32 v95, 0
    v_mov_b32 v98, 0
    v_mov_b32 v99, 0
    v_mov_b32 v102, 0
    v_mov_b32 v103, 0
    v_mov_b32 v106, 0
    v_mov_b32 v107, 0
    v_cndmask_b32 v18, 0, v31, vcc
    v_cndmask_b32 v19, 0, v32, vcc
    v_cndmask_b32 v20, 0, v33, vcc
    v_mov_b32 v88, v24
    v_and_b32 v89, 0xffff, v24
    v_mov_b32 v92, v26
    v_and_b32 v93, 0xffff, v26
    v_add_f32 v36, v18, v28
    v_sub_f32 v36, 0, v36
    v_cvt_pk_bf16_f32 v37, v36, v36
    v_and_b32 v39, 0xffff0000, v37
    v_sub_f32 v36, v36, v39
    v_cvt_pk_bf16_f32 v38, v36, v36
    v_and_b32 v39, 0xffff0000, v38
    v_sub_f32 v36, v36, v39
    v_bfi_b32 v96, s61, v37, v38
    v_cvt_pk_bf16_f32 v97, v36, 0
    v_add_f32 v36, v19, v29
    v_sub_f32 v36, 0, v36
    v_cvt_pk_bf16_f32 v37, v36, v36
    v_and_b32 v39, 0xffff0000, v37
    v_sub_f32 v36, v36, v39
    v_cvt_pk_bf16_f32 v38, v36, v36
    v_and_b32 v39, 0xffff0000, v38
    v_sub_f32 v36, v36, v39
    v_bfi_b32 v100, s61, v37, v38
    v_cvt_pk_bf16_f32 v101, v36, 0
    v_add_f32 v36, v20, v30
    v_sub_f32 v36, 0, v36
    v_cvt_pk_bf16_f32 v37, v36, v36
    v_and_b32 v39, 0xffff0000, v37
    v_sub_f32 v36, v36, v39
    v_cvt_pk_bf16_f32 v38, v36, v36
    v_and_b32 v39, 0xffff0000, v38
    v_sub_f32 v36, v36, v39
    v_bfi_b32 v104, s61, v37, v38
    v_cvt_pk_bf16_f32 v105, v36, 0
    s_nop 1
    v_mfma_f32_32x32x16_bf16 v[128:143], v[96:99], v[88:91], v[128:143]
    v_mfma_f32_32x32x16_bf16 v[176:191], v[96:99], v[92:95], v[176:191]
    v_mfma_f32_32x32x16_bf16 v[144:159], v[100:103], v[88:91], v[144:159]
    v_mfma_f32_32x32x16_bf16 v[192:207], v[100:103], v[92:95], v[192:207]
    v_mfma_f32_32x32x16_bf16 v[160:175], v[104:107], v[88:91], v[160:175]
    v_mfma_f32_32x32x16_bf16 v[208:223], v[104:107], v[92:95], v[208:223]
    v_rcp_f32 v36, v25
    v_rcp_f32 v37, v27
    s_cmp_eq_u32 s44, 0
    s_cbranch_scc0 K1_EPI_ATT
    v_mul_f32 v38, 0xc0135761, v36
    v_mul_f32 v40, v36, v36
    v_mul_f32 v40, v40, v36
    v_mul_f32 v40, 0xbdd2d3e8, v40
    v_mul_f32 v42, v25, v25
    v_mul_f32 v39, 0xc0135761, v37
    v_mul_f32 v41, v37, v37
    v_mul_f32 v41, v41, v37
    v_mul_f32 v41, 0xbdd2d3e8, v41
    v_mul_f32 v43, v27, v27
    v_and_b32 v84, 15, v2
    v_lshlrev_b32 v84, 4, v84
    v_lshl_add_u32 v84, v3, 8, v84
    v_lshrrev_b32 v85, 4, v2
    v_lshl_add_u32 v84, v85, 10, v84
    s_lshl_b32 s60, s42, 11
    v_add_u32 v44, s60, v84
    v_xor_b32 v45, 2048, v44
    s_lshr_b32 s60, s46, 6
    s_add_u32 s60, s60, s41
    s_mul_i32 s60, s60, 74
    s_mul_i32 s61, s45, 3
    s_add_u32 s60, s60, s61
    s_add_u32 s60, s60, 20
    s_lshl_b32 s60, s60, 12
    s_mul_i32 s61, s42, 4608
    s_add_u32 s70, s60, s61
    s_add_u32 s72, s70, 4096
    s_mul_i32 s61, s42, 7680
    s_add_u32 s71, s60, s61
    s_add_u32 s71, s71, 512
    s_nop 7
    v_pk_mul_f32 v[48:49], v[128:129], v[128:129]
    v_pk_mul_f32 v[50:51], v[130:131], v[130:131]
    v_pk_mul_f32 v[52:53], v[132:133], v[132:133]
    v_pk_mul_f32 v[54:55], v[134:135], v[134:135]
    v_pk_fma_f32 v[48:49], v[48:49], v[40:41], v[38:39] op_sel:[0,0,0] op_sel_hi:[1,0,0]
    v_pk_fma_f32 v[50:51], v[50:51], v[40:41], v[38:39] op_sel:[0,0,0] op_sel_hi:[1,0,0]
    v_pk_fma_f32 v[52:53], v[52:53], v[40:41], v[38:39] op_sel:[0,0,0] op_sel_hi:[1,0,0]
    v_pk_fma_f32 v[54:55], v[54:55], v[40:41], v[38:39] op_sel:[0,0,0] op_sel_hi:[1,0,0]
    v_pk_mul_f32 v[48:49], v[48:49], v[128:129]
    v_pk_mul_f32 v[50:51], v[50:51], v[130:131]
    v_pk_mul_f32 v[52:53], v[52:53], v[132:133]
    v_pk_mul_f32 v[54:55], v[54:55], v[134:135]
    v_exp_f32 v48, v48
    v_exp_f32 v49, v49
    v_exp_f32 v50, v50
    v_exp_f32 v51, v51
    v_exp_f32 v52, v52
    v_exp_f32 v53, v53
    v_exp_f32 v54, v54
    v_exp_f32 v55, v55
    v_pk_mul_f32 v[56:57], v[128:129], v[136:137]
    v_pk_mul_f32 v[58:59], v[130:131], v[138:139]
    v_pk_mul_f32 v[60:61], v[132:133], v[140:141]
    v_pk_mul_f32 v[62:63], v[134:135], v[142:143]
    v_pk_fma_f32 v[48:49], v[48:49], v[42:43], v[42:43] op_sel:[0,0,0] op_sel_hi:[1,0,0]
    v_pk_fma_f32 v[50:51], v[50:51], v[42:43], v[42:43] op_sel:[0,0,0] op_sel_hi:[1,0,0]
    v_pk_fma_f32 v[52:53], v[52:53], v[42:43], v[42:43] op_sel:[0,0,0] op_sel_hi:[1,0,0]
    v_pk_fma_f32 v[54:55], v[54:55], v[42:43], v[42:43] op_sel:[0,0,0] op_sel_hi:[1,0,0]
    v_rcp_f32 v48, v48
    v_rcp_f32 v49, v49
    v_rcp_f32 v50, v50
    v_rcp_f32 v51, v51
    v_rcp_f32 v52, v52
    v_rcp_f32 v53, v53
    v_rcp_f32 v54, v54
    v_rcp_f32 v55, v55
    s_nop 0
    v_pk_mul_f32 v[56:57], v[56:57], v[48:49]
    v_pk_mul_f32 v[58:59], v[58:59], v[50:51]
    v_pk_mul_f32 v[60:61], v[60:61], v[52:53]
    v_pk_mul_f32 v[62:63], v[62:63], v[54:55]
    v_cvt_pk_bf16_f32 v64, v56, v57
    v_cvt_pk_bf16_f32 v65, v58, v59
    v_cvt_pk_bf16_f32 v66, v60, v61
    v_cvt_pk_bf16_f32 v67, v62, v63
    buffer_store_dwordx4 v[64:67], v44, s[20:23], s70 offen sc1
    v_pk_mul_f32 v[48:49], v[144:145], v[144:145]
    v_pk_mul_f32 v[50:51], v[146:147], v[146:147]
    v_pk_mul_f32 v[52:53], v[148:149], v[148:149]
    v_pk_mul_f32 v[54:55], v[150:151], v[150:151]
    v_pk_fma_f32 v[48:49], v[48:49], v[40:41], v[38:39] op_sel:[0,0,0] op_sel_hi:[1,0,0]
    v_pk_fma_f32 v[50:51], v[50:51], v[40:41], v[38:39] op_sel:[0,0,0] op_sel_hi:[1,0,0]
    v_pk_fma_f32 v[52:53], v[52:53], v[40:41], v[38:39] op_sel:[0,0,0] op_sel_hi:[1,0,0]
    v_pk_fma_f32 v[54:55], v[54:55], v[40:41], v[38:39] op_sel:[0,0,0] op_sel_hi:[1,0,0]
    v_pk_mul_f32 v[48:49], v[48:49], v[144:145]
    v_pk_mul_f32 v[50:51], v[50:51], v[146:147]
    v_pk_mul_f32 v[52:53], v[52:53], v[148:149]
    v_pk_mul_f32 v[54:55], v[54:55], v[150:151]
    v_exp_f32 v48, v48
    v_exp_f32 v49, v49
    v_exp_f32 v50, v50
    v_exp_f32 v51, v51
    v_exp_f32 v52, v52
    v_exp_f32 v53, v53
    v_exp_f32 v54, v54
    v_exp_f32 v55, v55
    v_pk_mul_f32 v[56:57], v[144:145], v[152:153]
    v_pk_mul_f32 v[58:59], v[146:147], v[154:155]
    v_pk_mul_f32 v[60:61], v[148:149], v[156:157]
    v_pk_mul_f32 v[62:63], v[150:151], v[158:159]
    v_pk_fma_f32 v[48:49], v[48:49], v[42:43], v[42:43] op_sel:[0,0,0] op_sel_hi:[1,0,0]
    v_pk_fma_f32 v[50:51], v[50:51], v[42:43], v[42:43] op_sel:[0,0,0] op_sel_hi:[1,0,0]
    v_pk_fma_f32 v[52:53], v[52:53], v[42:43], v[42:43] op_sel:[0,0,0] op_sel_hi:[1,0,0]
    v_pk_fma_f32 v[54:55], v[54:55], v[42:43], v[42:43] op_sel:[0,0,0] op_sel_hi:[1,0,0]
    v_rcp_f32 v48, v48
    v_rcp_f32 v49, v49
    v_rcp_f32 v50, v50
    v_rcp_f32 v51, v51
    v_rcp_f32 v52, v52
    v_rcp_f32 v53, v53
    v_rcp_f32 v54, v54
    v_rcp_f32 v55, v55
    s_nop 0
    v_pk_mul_f32 v[56:57], v[56:57], v[48:49]
    v_pk_mul_f32 v[58:59], v[58:59], v[50:51]
    v_pk_mul_f32 v[60:61], v[60:61], v[52:53]
    v_pk_mul_f32 v[62:63], v[62:63], v[54:55]
    v_cvt_pk_bf16_f32 v68, v56, v57
    v_cvt_pk_bf16_f32 v69, v58, v59
    v_cvt_pk_bf16_f32 v70, v60, v61
    v_cvt_pk_bf16_f32 v71, v62, v63
    buffer_store_dwordx4 v[68:71], v44, s[20:23], s71 offen sc1
    v_pk_mul_f32 v[48:49], v[160:161], v[160:161]
    v_pk_mul_f32 v[50:51], v[162:163], v[162:163]
    v_pk_mul_f32 v[52:53], v[164:165], v[164:165]
    v_pk_mul_f32 v[54:55], v[166:167], v[166:167]
    v_pk_fma_f32 v[48:49], v[48:49], v[40:41], v[38:39] op_sel:[0,0,0] op_sel_hi:[1,0,0]
    v_pk_fma_f32 v[50:51], v[50:51], v[40:41], v[38:39] op_sel:[0,0,0] op_sel_hi:[1,0,0]
    v_pk_fma_f32 v[52:53], v[52:53], v[40:41], v[38:39] op_sel:[0,0,0] op_sel_hi:[1,0,0]
    v_pk_fma_f32 v[54:55], v[54:55], v[40:41], v[38:39] op_sel:[0,0,0] op_sel_hi:[1,0,0]
    v_pk_mul_f32 v[48:49], v[48:49], v[160:161]
    v_pk_mul_f32 v[50:51], v[50:51], v[162:163]
    v_pk_mul_f32 v[52:53], v[52:53], v[164:165]
    v_pk_mul_f32 v[54:55], v[54:55], v[166:167]
    v_exp_f32 v48, v48
    v_exp_f32 v49, v49
    v_exp_f32 v50, v50
    v_exp_f32 v51, v51
    v_exp_f32 v52, v52
    v_exp_f32 v53, v53
    v_exp_f32 v54, v54
    v_exp_f32 v55, v55
    v_pk_mul_f32 v[56:57], v[160:161], v[168:169]
    v_pk_mul_f32 v[58:59], v[162:163], v[170:171]
    v_pk_mul_f32 v[60:61], v[164:165], v[172:173]
    v_pk_mul_f32 v[62:63], v[166:167], v[174:175]
    v_pk_fma_f32 v[48:49], v[48:49], v[42:43], v[42:43] op_sel:[0,0,0] op_sel_hi:[1,0,0]
    v_pk_fma_f32 v[50:51], v[50:51], v[42:43], v[42:43] op_sel:[0,0,0] op_sel_hi:[1,0,0]
    v_pk_fma_f32 v[52:53], v[52:53], v[42:43], v[42:43] op_sel:[0,0,0] op_sel_hi:[1,0,0]
    v_pk_fma_f32 v[54:55], v[54:55], v[42:43], v[42:43] op_sel:[0,0,0] op_sel_hi:[1,0,0]
    v_rcp_f32 v48, v48
    v_rcp_f32 v49, v49
    v_rcp_f32 v50, v50
    v_rcp_f32 v51, v51
    v_rcp_f32 v52, v52
    v_rcp_f32 v53, v53
    v_rcp_f32 v54, v54
    v_rcp_f32 v55, v55
    s_nop 0
    v_pk_mul_f32 v[56:57], v[56:57], v[48:49]
    v_pk_mul_f32 v[58:59], v[58:59], v[50:51]
    v_pk_mul_f32 v[60:61], v[60:61], v[52:53]
    v_pk_mul_f32 v[62:63], v[62:63], v[54:55]
    v_cvt_pk_bf16_f32 v64, v56, v57
    v_cvt_pk_bf16_f32 v65, v58, v59
    v_cvt_pk_bf16_f32 v66, v60, v61
    v_cvt_pk_bf16_f32 v67, v62, v63
    buffer_store_dwordx4 v[64:67], v44, s[20:23], s72 offen sc1
    v_pk_mul_f32 v[48:49], v[176:177], v[176:177]
    v_pk_mul_f32 v[50:51], v[178:179], v[178:179]
    v_pk_mul_f32 v[52:53], v[180:181], v[180:181]
    v_pk_mul_f32 v[54:55], v[182:183], v[182:183]
    v_pk_fma_f32 v[48:49], v[48:49], v[40:41], v[38:39] op_sel:[0,1,1] op_sel_hi:[1,1,1]
    v_pk_fma_f32 v[50:51], v[50:51], v[40:41], v[38:39] op_sel:[0,1,1] op_sel_hi:[1,1,1]
    v_pk_fma_f32 v[52:53], v[52:53], v[40:41], v[38:39] op_sel:[0,1,1] op_sel_hi:[1,1,1]
    v_pk_fma_f32 v[54:55], v[54:55], v[40:41], v[38:39] op_sel:[0,1,1] op_sel_hi:[1,1,1]
    v_pk_mul_f32 v[48:49], v[48:49], v[176:177]
    v_pk_mul_f32 v[50:51], v[50:51], v[178:179]
    v_pk_mul_f32 v[52:53], v[52:53], v[180:181]
    v_pk_mul_f32 v[54:55], v[54:55], v[182:183]
    v_exp_f32 v48, v48
    v_exp_f32 v49, v49
    v_exp_f32 v50, v50
    v_exp_f32 v51, v51
    v_exp_f32 v52, v52
    v_exp_f32 v53, v53
    v_exp_f32 v54, v54
    v_exp_f32 v55, v55
    v_pk_mul_f32 v[56:57], v[176:177], v[184:185]
    v_pk_mul_f32 v[58:59], v[178:179], v[186:187]
    v_pk_mul_f32 v[60:61], v[180:181], v[188:189]
    v_pk_mul_f32 v[62:63], v[182:183], v[190:191]
    v_pk_fma_f32 v[48:49], v[48:49], v[42:43], v[42:43] op_sel:[0,1,1] op_sel_hi:[1,1,1]
    v_pk_fma_f32 v[50:51], v[50:51], v[42:43], v[42:43] op_sel:[0,1,1] op_sel_hi:[1,1,1]
    v_pk_fma_f32 v[52:53], v[52:53], v[42:43], v[42:43] op_sel:[0,1,1] op_sel_hi:[1,1,1]
    v_pk_fma_f32 v[54:55], v[54:55], v[42:43], v[42:43] op_sel:[0,1,1] op_sel_hi:[1,1,1]
    v_rcp_f32 v48, v48
    v_rcp_f32 v49, v49
    v_rcp_f32 v50, v50
    v_rcp_f32 v51, v51
    v_rcp_f32 v52, v52
    v_rcp_f32 v53, v53
    v_rcp_f32 v54, v54
    v_rcp_f32 v55, v55
    s_nop 0
    v_pk_mul_f32 v[56:57], v[56:57], v[48:49]
    v_pk_mul_f32 v[58:59], v[58:59], v[50:51]
    v_pk_mul_f32 v[60:61], v[60:61], v[52:53]
    v_pk_mul_f32 v[62:63], v[62:63], v[54:55]
    v_cvt_pk_bf16_f32 v68, v56, v57
    v_cvt_pk_bf16_f32 v69, v58, v59
    v_cvt_pk_bf16_f32 v70, v60, v61
    v_cvt_pk_bf16_f32 v71, v62, v63
    buffer_store_dwordx4 v[68:71], v45, s[20:23], s70 offen sc1
    v_pk_mul_f32 v[48:49], v[192:193], v[192:193]
    v_pk_mul_f32 v[50:51], v[194:195], v[194:195]
    v_pk_mul_f32 v[52:53], v[196:197], v[196:197]
    v_pk_mul_f32 v[54:55], v[198:199], v[198:199]
    v_pk_fma_f32 v[48:49], v[48:49], v[40:41], v[38:39] op_sel:[0,1,1] op_sel_hi:[1,1,1]
    v_pk_fma_f32 v[50:51], v[50:51], v[40:41], v[38:39] op_sel:[0,1,1] op_sel_hi:[1,1,1]
    v_pk_fma_f32 v[52:53], v[52:53], v[40:41], v[38:39] op_sel:[0,1,1] op_sel_hi:[1,1,1]
    v_pk_fma_f32 v[54:55], v[54:55], v[40:41], v[38:39] op_sel:[0,1,1] op_sel_hi:[1,1,1]
    v_pk_mul_f32 v[48:49], v[48:49], v[192:193]
    v_pk_mul_f32 v[50:51], v[50:51], v[194:195]
    v_pk_mul_f32 v[52:53], v[52:53], v[196:197]
    v_pk_mul_f32 v[54:55], v[54:55], v[198:199]
    v_exp_f32 v48, v48
    v_exp_f32 v49, v49
    v_exp_f32 v50, v50
    v_exp_f32 v51, v51
    v_exp_f32 v52, v52
    v_exp_f32 v53, v53
    v_exp_f32 v54, v54
    v_exp_f32 v55, v55
    v_pk_mul_f32 v[56:57], v[192:193], v[200:201]
    v_pk_mul_f32 v[58:59], v[194:195], v[202:203]
    v_pk_mul_f32 v[60:61], v[196:197], v[204:205]
    v_pk_mul_f32 v[62:63], v[198:199], v[206:207]
    v_pk_fma_f32 v[48:49], v[48:49], v[42:43], v[42:43] op_sel:[0,1,1] op_sel_hi:[1,1,1]
    v_pk_fma_f32 v[50:51], v[50:51], v[42:43], v[42:43] op_sel:[0,1,1] op_sel_hi:[1,1,1]
    v_pk_fma_f32 v[52:53], v[52:53], v[42:43], v[42:43] op_sel:[0,1,1] op_sel_hi:[1,1,1]
    v_pk_fma_f32 v[54:55], v[54:55], v[42:43], v[42:43] op_sel:[0,1,1] op_sel_hi:[1,1,1]
    v_rcp_f32 v48, v48
    v_rcp_f32 v49, v49
    v_rcp_f32 v50, v50
    v_rcp_f32 v51, v51
    v_rcp_f32 v52, v52
    v_rcp_f32 v53, v53
    v_rcp_f32 v54, v54
    v_rcp_f32 v55, v55
    s_nop 0
    v_pk_mul_f32 v[56:57], v[56:57], v[48:49]
    v_pk_mul_f32 v[58:59], v[58:59], v[50:51]
    v_pk_mul_f32 v[60:61], v[60:61], v[52:53]
    v_pk_mul_f32 v[62:63], v[62:63], v[54:55]
    v_cvt_pk_bf16_f32 v64, v56, v57
    v_cvt_pk_bf16_f32 v65, v58, v59
    v_cvt_pk_bf16_f32 v66, v60, v61
    v_cvt_pk_bf16_f32 v67, v62, v63
    buffer_store_dwordx4 v[64:67], v45, s[20:23], s71 offen sc1
    v_pk_mul_f32 v[48:49], v[208:209], v[208:209]
    v_pk_mul_f32 v[50:51], v[210:211], v[210:211]
    v_pk_mul_f32 v[52:53], v[212:213], v[212:213]
    v_pk_mul_f32 v[54:55], v[214:215], v[214:215]
    v_pk_fma_f32 v[48:49], v[48:49], v[40:41], v[38:39] op_sel:[0,1,1] op_sel_hi:[1,1,1]
    v_pk_fma_f32 v[50:51], v[50:51], v[40:41], v[38:39] op_sel:[0,1,1] op_sel_hi:[1,1,1]
    v_pk_fma_f32 v[52:53], v[52:53], v[40:41], v[38:39] op_sel:[0,1,1] op_sel_hi:[1,1,1]
    v_pk_fma_f32 v[54:55], v[54:55], v[40:41], v[38:39] op_sel:[0,1,1] op_sel_hi:[1,1,1]
    v_pk_mul_f32 v[48:49], v[48:49], v[208:209]
    v_pk_mul_f32 v[50:51], v[50:51], v[210:211]
    v_pk_mul_f32 v[52:53], v[52:53], v[212:213]
    v_pk_mul_f32 v[54:55], v[54:55], v[214:215]
    v_exp_f32 v48, v48
    v_exp_f32 v49, v49
    v_exp_f32 v50, v50
    v_exp_f32 v51, v51
    v_exp_f32 v52, v52
    v_exp_f32 v53, v53
    v_exp_f32 v54, v54
    v_exp_f32 v55, v55
    v_pk_mul_f32 v[56:57], v[208:209], v[216:217]
    v_pk_mul_f32 v[58:59], v[210:211], v[218:219]
    v_pk_mul_f32 v[60:61], v[212:213], v[220:221]
    v_pk_mul_f32 v[62:63], v[214:215], v[222:223]
    v_pk_fma_f32 v[48:49], v[48:49], v[42:43], v[42:43] op_sel:[0,1,1] op_sel_hi:[1,1,1]
    v_pk_fma_f32 v[50:51], v[50:51], v[42:43], v[42:43] op_sel:[0,1,1] op_sel_hi:[1,1,1]
    v_pk_fma_f32 v[52:53], v[52:53], v[42:43], v[42:43] op_sel:[0,1,1] op_sel_hi:[1,1,1]
    v_pk_fma_f32 v[54:55], v[54:55], v[42:43], v[42:43] op_sel:[0,1,1] op_sel_hi:[1,1,1]
    v_rcp_f32 v48, v48
    v_rcp_f32 v49, v49
    v_rcp_f32 v50, v50
    v_rcp_f32 v51, v51
    v_rcp_f32 v52, v52
    v_rcp_f32 v53, v53
    v_rcp_f32 v54, v54
    v_rcp_f32 v55, v55
    s_nop 0
    v_pk_mul_f32 v[56:57], v[56:57], v[48:49]
    v_pk_mul_f32 v[58:59], v[58:59], v[50:51]
    v_pk_mul_f32 v[60:61], v[60:61], v[52:53]
    v_pk_mul_f32 v[62:63], v[62:63], v[54:55]
    v_cvt_pk_bf16_f32 v68, v56, v57
    v_cvt_pk_bf16_f32 v69, v58, v59
    v_cvt_pk_bf16_f32 v70, v60, v61
    v_cvt_pk_bf16_f32 v71, v62, v63
    buffer_store_dwordx4 v[68:71], v45, s[20:23], s72 offen sc1
    s_lshr_b32 s61, s46, 3
    s_mov_b32 s62, 32
    s_mov_b32 s63, 13599232
    s_branch P1_DONE
K1_EPI_ATT:
    s_barrier
    s_lshl_b32 s60, s40, 5
    v_add_u32 v84, s60, v2
    v_xor_b32 v85, 32, v84
    s_mul_i32 s61, s42, 96
    v_lshlrev_b32 v86, 4, v3
    v_add_u32 v86, s61, v86
    s_movk_i32 s62, 392
    v_mad_u32_u24 v38, v84, s62, v86
    v_mad_u32_u24 v39, v85, s62, v86
    s_nop 7
    v_pk_mul_f32 v[128:129], v[128:129], v[36:37] op_sel:[0,0] op_sel_hi:[1,0]
    v_pk_mul_f32 v[130:131], v[130:131], v[36:37] op_sel:[0,0] op_sel_hi:[1,0]
    v_pk_mul_f32 v[132:133], v[132:133], v[36:37] op_sel:[0,0] op_sel_hi:[1,0]
    v_pk_mul_f32 v[134:135], v[134:135], v[36:37] op_sel:[0,0] op_sel_hi:[1,0]
    v_pk_mul_f32 v[136:137], v[136:137], v[36:37] op_sel:[0,0] op_sel_hi:[1,0]
    v_pk_mul_f32 v[138:139], v[138:139], v[36:37] op_sel:[0,0] op_sel_hi:[1,0]
    v_pk_mul_f32 v[140:141], v[140:141], v[36:37] op_sel:[0,0] op_sel_hi:[1,0]
    v_pk_mul_f32 v[142:143], v[142:143], v[36:37] op_sel:[0,0] op_sel_hi:[1,0]
    v_cvt_pk_bf16_f32 v48, v128, v129
    v_cvt_pk_bf16_f32 v49, v130, v131
    v_cvt_pk_bf16_f32 v50, v132, v133
    v_cvt_pk_bf16_f32 v51, v134, v135
    v_cvt_pk_bf16_f32 v52, v136, v137
    v_cvt_pk_bf16_f32 v53, v138, v139
    v_cvt_pk_bf16_f32 v54, v140, v141
    v_cvt_pk_bf16_f32 v55, v142, v143
    ds_write_b64 v38, v[48:49] offset:0
    ds_write_b64 v38, v[50:51] offset:8
    ds_write_b64 v38, v[52:53] offset:192
    ds_write_b64 v38, v[54:55] offset:200
    v_pk_mul_f32 v[144:145], v[144:145], v[36:37] op_sel:[0,0] op_sel_hi:[1,0]
    v_pk_mul_f32 v[146:147], v[146:147], v[36:37] op_sel:[0,0] op_sel_hi:[1,0]
    v_pk_mul_f32 v[148:149], v[148:149], v[36:37] op_sel:[0,0] op_sel_hi:[1,0]
    v_pk_mul_f32 v[150:151], v[150:151], v[36:37] op_sel:[0,0] op_sel_hi:[1,0]
    v_pk_mul_f32 v[152:153], v[152:153], v[36:37] op_sel:[0,0] op_sel_hi:[1,0]
    v_pk_mul_f32 v[154:155], v[154:155], v[36:37] op_sel:[0,0] op_sel_hi:[1,0]
    v_pk_mul_f32 v[156:157], v[156:157], v[36:37] op_sel:[0,0] op_sel_hi:[1,0]
    v_pk_mul_f32 v[158:159], v[158:159], v[36:37] op_sel:[0,0] op_sel_hi:[1,0]
    v_cvt_pk_bf16_f32 v56, v144, v145
    v_cvt_pk_bf16_f32 v57, v146, v147
    v_cvt_pk_bf16_f32 v58, v148, v149
    v_cvt_pk_bf16_f32 v59, v150, v151
    v_cvt_pk_bf16_f32 v60, v152, v153
    v_cvt_pk_bf16_f32 v61, v154, v155
    v_cvt_pk_bf16_f32 v62, v156, v157
    v_cvt_pk_bf16_f32 v63, v158, v159
    ds_write_b64 v38, v[56:57] offset:32
    ds_write_b64 v38, v[58:59] offset:40
    ds_write_b64 v38, v[60:61] offset:224
    ds_write_b64 v38, v[62:63] offset:232
    v_pk_mul_f32 v[160:161], v[160:161], v[36:37] op_sel:[0,0] op_sel_hi:[1,0]
    v_pk_mul_f32 v[162:163], v[162:163], v[36:37] op_sel:[0,0] op_sel_hi:[1,0]
    v_pk_mul_f32 v[164:165], v[164:165], v[36:37] op_sel:[0,0] op_sel_hi:[1,0]
    v_pk_mul_f32 v[166:167], v[166:167], v[36:37] op_sel:[0,0] op_sel_hi:[1,0]
    v_pk_mul_f32 v[168:169], v[168:169], v[36:37] op_sel:[0,0] op_sel_hi:[1,0]
    v_pk_mul_f32 v[170:171], v[170:171], v[36:37] op_sel:[0,0] op_sel_hi:[1,0]
    v_pk_mul_f32 v[172:173], v[172:173], v[36:37] op_sel:[0,0] op_sel_hi:[1,0]
    v_pk_mul_f32 v[174:175], v[174:175], v[36:37] op_sel:[0,0] op_sel_hi:[1,0]
    v_cvt_pk_bf16_f32 v48, v160, v161
    v_cvt_pk_bf16_f32 v49, v162, v163
    v_cvt_pk_bf16_f32 v50, v164, v165
    v_cvt_pk_bf16_f32 v51, v166, v167
    v_cvt_pk_bf16_f32 v52, v168, v169
    v_cvt_pk_bf16_f32 v53, v170, v171
    v_cvt_pk_bf16_f32 v54, v172, v173
    v_cvt_pk_bf16_f32 v55, v174, v175
    ds_write_b64 v38, v[48:49] offset:64
    ds_write_b64 v38, v[50:51] offset:72
    ds_write_b64 v38, v[52:53] offset:256
    ds_write_b64 v38, v[54:55] offset:264
    v_pk_mul_f32 v[176:177], v[176:177], v[36:37] op_sel:[0,1] op_sel_hi:[1,1]
    v_pk_mul_f32 v[178:179], v[178:179], v[36:37] op_sel:[0,1] op_sel_hi:[1,1]
    v_pk_mul_f32 v[180:181], v[180:181], v[36:37] op_sel:[0,1] op_sel_hi:[1,1]
    v_pk_mul_f32 v[182:183], v[182:183], v[36:37] op_sel:[0,1] op_sel_hi:[1,1]
    v_pk_mul_f32 v[184:185], v[184:185], v[36:37] op_sel:[0,1] op_sel_hi:[1,1]
    v_pk_mul_f32 v[186:187], v[186:187], v[36:37] op_sel:[0,1] op_sel_hi:[1,1]
    v_pk_mul_f32 v[188:189], v[188:189], v[36:37] op_sel:[0,1] op_sel_hi:[1,1]
    v_pk_mul_f32 v[190:191], v[190:191], v[36:37] op_sel:[0,1] op_sel_hi:[1,1]
    v_cvt_pk_bf16_f32 v56, v176, v177
    v_cvt_pk_bf16_f32 v57, v178, v179
    v_cvt_pk_bf16_f32 v58, v180, v181
    v_cvt_pk_bf16_f32 v59, v182, v183
    v_cvt_pk_bf16_f32 v60, v184, v185
    v_cvt_pk_bf16_f32 v61, v186, v187
    v_cvt_pk_bf16_f32 v62, v188, v189
    v_cvt_pk_bf16_f32 v63, v190, v191
    ds_write_b64 v39, v[56:57] offset:0
    ds_write_b64 v39, v[58:59] offset:8
    ds_write_b64 v39, v[60:61] offset:192
    ds_write_b64 v39, v[62:63] offset:200
    v_pk_mul_f32 v[192:193], v[192:193], v[36:37] op_sel:[0,1] op_sel_hi:[1,1]
    v_pk_mul_f32 v[194:195], v[194:195], v[36:37] op_sel:[0,1] op_sel_hi:[1,1]
    v_pk_mul_f32 v[196:197], v[196:197], v[36:37] op_sel:[0,1] op_sel_hi:[1,1]
    v_pk_mul_f32 v[198:199], v[198:199], v[36:37] op_sel:[0,1] op_sel_hi:[1,1]
    v_pk_mul_f32 v[200:201], v[200:201], v[36:37] op_sel:[0,1] op_sel_hi:[1,1]
    v_pk_mul_f32 v[202:203], v[202:203], v[36:37] op_sel:[0,1] op_sel_hi:[1,1]
    v_pk_mul_f32 v[204:205], v[204:205], v[36:37] op_sel:[0,1] op_sel_hi:[1,1]
    v_pk_mul_f32 v[206:207], v[206:207], v[36:37] op_sel:[0,1] op_sel_hi:[1,1]
    v_cvt_pk_bf16_f32 v48, v192, v193
    v_cvt_pk_bf16_f32 v49, v194, v195
    v_cvt_pk_bf16_f32 v50, v196, v197
    v_cvt_pk_bf16_f32 v51, v198, v199
    v_cvt_pk_bf16_f32 v52, v200, v201
    v_cvt_pk_bf16_f32 v53, v202, v203
    v_cvt_pk_bf16_f32 v54, v204, v205
    v_cvt_pk_bf16_f32 v55, v206, v207
    ds_write_b64 v39, v[48:49] offset:32
    ds_write_b64 v39, v[50:51] offset:40
    ds_write_b64 v39, v[52:53] offset:224
    ds_write_b64 v39, v[54:55] offset:232
    v_pk_mul_f32 v[208:209], v[208:209], v[36:37] op_sel:[0,1] op_sel_hi:[1,1]
    v_pk_mul_f32 v[210:211], v[210:211], v[36:37] op_sel:[0,1] op_sel_hi:[1,1]
    v_pk_mul_f32 v[212:213], v[212:213], v[36:37] op_sel:[0,1] op_sel_hi:[1,1]
    v_pk_mul_f32 v[214:215], v[214:215], v[36:37] op_sel:[0,1] op_sel_hi:[1,1]
    v_pk_mul_f32 v[216:217], v[216:217], v[36:37] op_sel:[0,1] op_sel_hi:[1,1]
    v_pk_mul_f32 v[218:219], v[218:219], v[36:37] op_sel:[0,1] op_sel_hi:[1,1]
    v_pk_mul_f32 v[220:221], v[220:221], v[36:37] op_sel:[0,1] op_sel_hi:[1,1]
    v_pk_mul_f32 v[222:223], v[222:223], v[36:37] op_sel:[0,1] op_sel_hi:[1,1]
    v_cvt_pk_bf16_f32 v56, v208, v209
    v_cvt_pk_bf16_f32 v57, v210, v211
    v_cvt_pk_bf16_f32 v58, v212, v213
    v_cvt_pk_bf16_f32 v59, v214, v215
    v_cvt_pk_bf16_f32 v60, v216, v217
    v_cvt_pk_bf16_f32 v61, v218, v219
    v_cvt_pk_bf16_f32 v62, v220, v221
    v_cvt_pk_bf16_f32 v63, v222, v223
    ds_write_b64 v39, v[56:57] offset:64
    ds_write_b64 v39, v[58:59] offset:72
    ds_write_b64 v39, v[60:61] offset:256
    ds_write_b64 v39, v[62:63] offset:264
    v_add_u32 v24, s60, v2
    v_add_u32 v25, s46, v24
    v_and_b32 v42, 15, v1
    v_lshrrev_b32 v43, 4, v1
    v_lshl_add_u32 v44, v42, 1, s60
    v_mul_u32_u24 v45, 392, v44
    v_lshl_add_u32 v26, v43, 4, v45
    v_lshl_add_u32 v30, v43, 3, v45
    v_subrev_u32 v44, 32, v44
    v_max_i32 v44, 0, v44
    v_mul_u32_u24 v45, 392, v44
    v_lshl_add_u32 v27, v43, 4, v45
    v_lshrrev_b32 v44, 2, v1
    v_lshl_add_u32 v44, v44, 1, s60
    v_and_b32 v46, 3, v1
    v_lshlrev_b32 v46, 3, v46
    v_mad_u32_u24 v28, v44, s62, v46
    v_subrev_u32 v44, 32, v44
    v_max_i32 v44, 0, v44
    v_mad_u32_u24 v29, v44, s62, v46
    v_mov_b32 v46, 0xf149f2ca
    s_add_i32 s61, s60, s46
    v_mov_b32 v38, 0
    v_mov_b32 v39, 0
    v_mov_b32 v48, 0
    v_mov_b32 v49, 0
    v_mov_b32 v50, 0
    v_mov_b32 v51, 0
    v_mov_b32 v76, 0
    v_mov_b32 v77, 0
    v_mov_b32 v78, 0
    v_mov_b32 v79, 0
    v_mov_b32 v104, 0
    v_mov_b32 v105, 0
    v_mov_b32 v106, 0
    v_mov_b32 v107, 0
    v_mov_b32 v132, 0
    v_mov_b32 v133, 0
    v_mov_b32 v134, 0
    v_mov_b32 v135, 0
    v_mov_b32 v160, 0
    v_mov_b32 v161, 0
    v_mov_b32 v162, 0
    v_mov_b32 v163, 0
    v_mov_b32 v188, 0
    v_mov_b32 v189, 0
    v_mov_b32 v190, 0
    v_mov_b32 v191, 0
    v_lshl_add_u32 v44, v43, 2, 0
    v_cmp_le_u32 s[52:53], v44, v42
    v_subrev_u32 v45, 16, v44
    s_nop 0
    v_cndmask_b32 v44, v45, v44, s[52:53]
    v_sub_u32 v45, v42, v44
    v_cmp_ge_u32 vcc, 7, v45
    v_lshl_add_u32 v45, v44, 1, s61
    v_cmp_le_i32 s[62:63], 0, v45
    s_and_b64 vcc, vcc, s[62:63]
    v_mov_b32 v45, 0xffff
    v_cndmask_b32 v47, v46, 0, vcc
    v_cndmask_b32 v224, v46, v47, s[52:53]
    v_cndmask_b32 v228, v47, v46, s[52:53]
    v_cndmask_b32 v45, 0, v45, s[52:53]
    v_or_b32 v38, v38, v45
    v_lshl_add_u32 v44, v43, 2, 1
    v_cmp_le_u32 s[54:55], v44, v42
    v_subrev_u32 v45, 16, v44
    s_nop 0
    v_cndmask_b32 v44, v45, v44, s[54:55]
    v_sub_u32 v45, v42, v44
    v_cmp_ge_u32 vcc, 7, v45
    v_lshl_add_u32 v45, v44, 1, s61
    v_cmp_le_i32 s[62:63], 0, v45
    s_and_b64 vcc, vcc, s[62:63]
    v_mov_b32 v45, 0xffff0000
    v_cndmask_b32 v47, v46, 0, vcc
    v_cndmask_b32 v225, v46, v47, s[54:55]
    v_cndmask_b32 v229, v47, v46, s[54:55]
    v_cndmask_b32 v45, 0, v45, s[54:55]
    v_or_b32 v38, v38, v45
    v_lshl_add_u32 v44, v43, 2, 2
    v_cmp_le_u32 s[56:57], v44, v42
    v_subrev_u32 v45, 16, v44
    s_nop 0
    v_cndmask_b32 v44, v45, v44, s[56:57]
    v_sub_u32 v45, v42, v44
    v_cmp_ge_u32 vcc, 7, v45
    v_lshl_add_u32 v45, v44, 1, s61
    v_cmp_le_i32 s[62:63], 0, v45
    s_and_b64 vcc, vcc, s[62:63]
    v_mov_b32 v45, 0xffff
    v_cndmask_b32 v47, v46, 0, vcc
    v_cndmask_b32 v226, v46, v47, s[56:57]
    v_cndmask_b32 v230, v47, v46, s[56:57]
    v_cndmask_b32 v45, 0, v45, s[56:57]
    v_or_b32 v39, v39, v45
    v_lshl_add_u32 v44, v43, 2, 3
    v_cmp_le_u32 s[58:59], v44, v42
    v_subrev_u32 v45, 16, v44
    s_nop 0
    v_cndmask_b32 v44, v45, v44, s[58:59]
    v_sub_u32 v45, v42, v44
    v_cmp_ge_u32 vcc, 7, v45
    v_lshl_add_u32 v45, v44, 1, s61
    v_cmp_le_i32 s[62:63], 0, v45
    s_and_b64 vcc, vcc, s[62:63]
    v_mov_b32 v45, 0xffff0000
    v_cndmask_b32 v47, v46, 0, vcc
    v_cndmask_b32 v227, v46, v47, s[58:59]
    v_cndmask_b32 v231, v47, v46, s[58:59]
    v_cndmask_b32 v45, 0, v45, s[58:59]
    v_or_b32 v39, v39, v45
    v_not_b32 v40, v38
    v_not_b32 v41, v39
    s_mov_b32 s51, 0
    s_cmp_eq_u32 s45, 10
    s_cselect_b32 s73, 2, 3
    s_waitcnt lgkmcnt(0)
    s_barrier
    s_mov_b32 exec_hi, 0xffff
    ds_read_b64 v[48:49], v26 offset:0
    ds_read_b64 v[76:77], v26 offset:392
    ds_read_b64 v[104:105], v26 offset:40
    ds_read_b64 v[132:133], v26 offset:432
    ds_read_b64 v[160:161], v26 offset:80
    ds_read_b64 v[188:189], v26 offset:472
    s_mov_b32 exec_hi, 0
    ds_read_b64 v[50:51], v26 offset:8
    ds_read_b64 v[78:79], v26 offset:400
    ds_read_b64 v[106:107], v26 offset:48
    ds_read_b64 v[134:135], v26 offset:440
    ds_read_b64 v[162:163], v26 offset:88
    ds_read_b64 v[190:191], v26 offset:480
    s_mov_b32 exec_hi, -1
    ds_read2_b64 v[52:55], v26 offset0:16 offset1:17
    ds_read2_b64 v[56:59], v27 offset0:16 offset1:17
    ds_read2_b64 v[80:83], v26 offset0:65 offset1:66
    ds_read2_b64 v[84:87], v27 offset0:65 offset1:66
    ds_read2_b64 v[108:111], v26 offset0:21 offset1:22
    ds_read2_b64 v[112:115], v27 offset0:21 offset1:22
    ds_read2_b64 v[136:139], v26 offset0:70 offset1:71
    ds_read2_b64 v[140:143], v27 offset0:70 offset1:71
    ds_read2_b64 v[164:167], v26 offset0:26 offset1:27
    ds_read2_b64 v[168:171], v27 offset0:26 offset1:27
    ds_read2_b64 v[192:195], v26 offset0:75 offset1:76
    ds_read2_b64 v[196:199], v27 offset0:75 offset1:76
    s_mov_b32 s52, 0x3ea52b5c
    s_waitcnt lgkmcnt(8)
    v_mfma_f32_16x16x32_bf16 v[68:71], v[52:55], v[48:51], v[224:227]
    v_mfma_f32_16x16x32_bf16 v[72:75], v[56:59], v[48:51], v[228:231]
    v_mfma_f32_16x16x32_bf16 v[96:99], v[80:83], v[76:79], v[224:227]
    v_mfma_f32_16x16x32_bf16 v[100:103], v[84:87], v[76:79], v[228:231]
    s_waitcnt lgkmcnt(4)
    v_mfma_f32_16x16x32_bf16 v[124:127], v[108:111], v[104:107], v[224:227]
    v_mfma_f32_16x16x32_bf16 v[128:131], v[112:115], v[104:107], v[228:231]
    v_mfma_f32_16x16x32_bf16 v[152:155], v[136:139], v[132:135], v[224:227]
    v_mfma_f32_16x16x32_bf16 v[156:159], v[140:143], v[132:135], v[228:231]
    s_waitcnt lgkmcnt(0)
    v_mfma_f32_16x16x32_bf16 v[180:183], v[164:167], v[160:163], v[224:227]
    v_mfma_f32_16x16x32_bf16 v[184:187], v[168:171], v[160:163], v[228:231]
    v_mfma_f32_16x16x32_bf16 v[208:211], v[192:195], v[188:191], v[224:227]
    v_mfma_f32_16x16x32_bf16 v[212:215], v[196:199], v[188:191], v[228:231]
    ds_read_b64_tr_b16 v[60:61], v29 offset:256
    ds_read_b64_tr_b16 v[62:63], v28 offset:256
    ds_read_b64_tr_b16 v[64:65], v29 offset:288
    ds_read_b64_tr_b16 v[66:67], v28 offset:288
    ds_read_b64_tr_b16 v[88:89], v29 offset:648
    ds_read_b64_tr_b16 v[90:91], v28 offset:648
    ds_read_b64_tr_b16 v[92:93], v29 offset:680
    ds_read_b64_tr_b16 v[94:95], v28 offset:680
    ds_read_b64_tr_b16 v[116:117], v29 offset:296
    ds_read_b64_tr_b16 v[118:119], v28 offset:296
    ds_read_b64_tr_b16 v[120:121], v29 offset:328
    ds_read_b64_tr_b16 v[122:123], v28 offset:328
    ds_read_b64_tr_b16 v[144:145], v29 offset:688
    ds_read_b64_tr_b16 v[146:147], v28 offset:688
    ds_read_b64_tr_b16 v[148:149], v29 offset:720
    ds_read_b64_tr_b16 v[150:151], v28 offset:720
    ds_read_b64_tr_b16 v[172:173], v29 offset:336
    ds_read_b64_tr_b16 v[174:175], v28 offset:336
    ds_read_b64_tr_b16 v[176:177], v29 offset:368
    ds_read_b64_tr_b16 v[178:179], v28 offset:368
    ds_read_b64_tr_b16 v[200:201], v29 offset:728
    ds_read_b64_tr_b16 v[202:203], v28 offset:728
    ds_read_b64_tr_b16 v[204:205], v29 offset:760
    ds_read_b64_tr_b16 v[206:207], v28 offset:760
    v_max_f32 v68, v72, v68
    v_max_f32 v69, v73, v69
    v_max_f32 v70, v74, v70
    v_max_f32 v71, v75, v71
    v_max_f32 v96, v100, v96
    v_max_f32 v97, v101, v97
    v_max_f32 v98, v102, v98
    v_max_f32 v99, v103, v99
    v_max_f32 v124, v128, v124
    v_max_f32 v125, v129, v125
    v_max_f32 v126, v130, v126
    v_max_f32 v127, v131, v127
    v_max_f32 v152, v156, v152
    v_max_f32 v153, v157, v153
    v_max_f32 v154, v158, v154
    v_max_f32 v155, v159, v155
    v_max_f32 v180, v184, v180
    v_max_f32 v181, v185, v181
    v_max_f32 v182, v186, v182
    v_max_f32 v183, v187, v183
    v_max_f32 v208, v212, v208
    v_max_f32 v209, v213, v209
    v_max_f32 v210, v214, v210
    v_max_f32 v211, v215, v211
    v_max_f32 v73, v68, v69
    v_max_f32 v101, v96, v97
    v_max_f32 v129, v124, v125
    v_max_f32 v157, v152, v153
    v_max_f32 v185, v180, v181
    v_max_f32 v213, v208, v209
    v_max3_f32 v73, v73, v70, v71
    v_max3_f32 v101, v101, v98, v99
    v_max3_f32 v129, v129, v126, v127
    v_max3_f32 v157, v157, v154, v155
    v_max3_f32 v185, v185, v182, v183
    v_max3_f32 v213, v213, v210, v211
    v_permlane16_swap_b32 v73, v101
    v_permlane16_swap_b32 v129, v157
    v_permlane16_swap_b32 v185, v213
    v_max_f32 v72, v73, v101
    v_max_f32 v128, v129, v157
    v_max_f32 v184, v185, v213
    v_max_f32 v100, v73, v101
    v_max_f32 v156, v129, v157
    v_max_f32 v212, v185, v213
    v_permlane32_swap_b32 v72, v100
    v_permlane32_swap_b32 v128, v156
    v_permlane32_swap_b32 v184, v212
    v_max_f32 v72, v72, v100
    v_max_f32 v128, v128, v156
    v_max_f32 v184, v184, v212
    v_mul_f32 v72, 0xbea52b5c, v72
    v_mul_f32 v128, 0xbea52b5c, v128
    v_mul_f32 v184, 0xbea52b5c, v184
    v_mov_b32 v100, v72
    v_mov_b32 v156, v128
    v_mov_b32 v212, v184
    v_permlane16_swap_b32 v72, v100
    v_permlane16_swap_b32 v128, v156
    v_permlane16_swap_b32 v184, v212
    v_pk_fma_f32 v[68:69], v[68:69], s[52:53], v[72:73] op_sel_hi:[1,0,0]
    v_pk_fma_f32 v[70:71], v[70:71], s[52:53], v[72:73] op_sel_hi:[1,0,0]
    v_pk_fma_f32 v[96:97], v[96:97], s[52:53], v[100:101] op_sel_hi:[1,0,0]
    v_pk_fma_f32 v[98:99], v[98:99], s[52:53], v[100:101] op_sel_hi:[1,0,0]
    v_pk_fma_f32 v[124:125], v[124:125], s[52:53], v[128:129] op_sel_hi:[1,0,0]
    v_pk_fma_f32 v[126:127], v[126:127], s[52:53], v[128:129] op_sel_hi:[1,0,0]
    v_pk_fma_f32 v[152:153], v[152:153], s[52:53], v[156:157] op_sel_hi:[1,0,0]
    v_pk_fma_f32 v[154:155], v[154:155], s[52:53], v[156:157] op_sel_hi:[1,0,0]
    v_pk_fma_f32 v[180:181], v[180:181], s[52:53], v[184:185] op_sel_hi:[1,0,0]
    v_pk_fma_f32 v[182:183], v[182:183], s[52:53], v[184:185] op_sel_hi:[1,0,0]
    v_pk_fma_f32 v[208:209], v[208:209], s[52:53], v[212:213] op_sel_hi:[1,0,0]
    v_pk_fma_f32 v[210:211], v[210:211], s[52:53], v[212:213] op_sel_hi:[1,0,0]
    v_exp_f32 v68, v68
    v_exp_f32 v69, v69
    v_exp_f32 v70, v70
    v_exp_f32 v71, v71
    v_exp_f32 v96, v96
    v_exp_f32 v97, v97
    v_exp_f32 v98, v98
    v_exp_f32 v99, v99
    v_exp_f32 v124, v124
    v_exp_f32 v125, v125
    v_exp_f32 v126, v126
    v_exp_f32 v127, v127
    v_exp_f32 v152, v152
    v_exp_f32 v153, v153
    v_exp_f32 v154, v154
    v_exp_f32 v155, v155
    v_exp_f32 v180, v180
    v_exp_f32 v181, v181
    v_exp_f32 v182, v182
    v_exp_f32 v183, v183
    v_exp_f32 v208, v208
    v_exp_f32 v209, v209
    v_exp_f32 v210, v210
    v_exp_f32 v211, v211
    v_pk_add_f32 v[74:75], v[68:69], v[70:71]
    v_pk_add_f32 v[102:103], v[96:97], v[98:99]
    v_pk_add_f32 v[130:131], v[124:125], v[126:127]
    v_pk_add_f32 v[158:159], v[152:153], v[154:155]
    v_pk_add_f32 v[186:187], v[180:181], v[182:183]
    v_pk_add_f32 v[214:215], v[208:209], v[210:211]
    v_add_f32 v73, v74, v75
    v_add_f32 v101, v102, v103
    v_add_f32 v129, v130, v131
    v_add_f32 v157, v158, v159
    v_add_f32 v185, v186, v187
    v_add_f32 v213, v214, v215
    v_permlane16_swap_b32 v73, v101
    v_permlane16_swap_b32 v129, v157
    v_permlane16_swap_b32 v185, v213
    v_add_f32 v72, v73, v101
    v_add_f32 v128, v129, v157
    v_add_f32 v184, v185, v213
    v_add_f32 v100, v73, v101
    v_add_f32 v156, v129, v157
    v_add_f32 v212, v185, v213
    v_permlane32_swap_b32 v72, v100
    v_permlane32_swap_b32 v128, v156
    v_permlane32_swap_b32 v184, v212
    v_add_f32 v72, v72, v100
    v_add_f32 v128, v128, v156
    v_add_f32 v184, v184, v212
    v_rcp_f32 v72, v72
    v_rcp_f32 v128, v128
    v_rcp_f32 v184, v184
    v_mov_b32 v100, v72
    v_mov_b32 v156, v128
    v_mov_b32 v212, v184
    v_permlane16_swap_b32 v72, v100
    v_permlane16_swap_b32 v128, v156
    v_permlane16_swap_b32 v184, v212
    v_pk_mul_f32 v[68:69], v[68:69], v[72:73] op_sel_hi:[1,0]
    v_pk_mul_f32 v[70:71], v[70:71], v[72:73] op_sel_hi:[1,0]
    v_pk_mul_f32 v[96:97], v[96:97], v[100:101] op_sel_hi:[1,0]
    v_pk_mul_f32 v[98:99], v[98:99], v[100:101] op_sel_hi:[1,0]
    v_pk_mul_f32 v[124:125], v[124:125], v[128:129] op_sel_hi:[1,0]
    v_pk_mul_f32 v[126:127], v[126:127], v[128:129] op_sel_hi:[1,0]
    v_pk_mul_f32 v[152:153], v[152:153], v[156:157] op_sel_hi:[1,0]
    v_pk_mul_f32 v[154:155], v[154:155], v[156:157] op_sel_hi:[1,0]
    v_pk_mul_f32 v[180:181], v[180:181], v[184:185] op_sel_hi:[1,0]
    v_pk_mul_f32 v[182:183], v[182:183], v[184:185] op_sel_hi:[1,0]
    v_pk_mul_f32 v[208:209], v[208:209], v[212:213] op_sel_hi:[1,0]
    v_pk_mul_f32 v[210:211], v[210:211], v[212:213] op_sel_hi:[1,0]
    v_cvt_pk_bf16_f32 v72, v68, v69
    v_cvt_pk_bf16_f32 v73, v70, v71
    v_cvt_pk_bf16_f32 v100, v96, v97
    v_cvt_pk_bf16_f32 v101, v98, v99
    v_cvt_pk_bf16_f32 v128, v124, v125
    v_cvt_pk_bf16_f32 v129, v126, v127
    v_cvt_pk_bf16_f32 v156, v152, v153
    v_cvt_pk_bf16_f32 v157, v154, v155
    v_cvt_pk_bf16_f32 v184, v180, v181
    v_cvt_pk_bf16_f32 v185, v182, v183
    v_cvt_pk_bf16_f32 v212, v208, v209
    v_cvt_pk_bf16_f32 v213, v210, v211
    s_waitcnt lgkmcnt(0)
    v_and_b32 v48, v72, v40
    v_and_b32 v49, v73, v41
    v_and_b32 v50, v72, v38
    v_and_b32 v51, v73, v39
    v_and_b32 v76, v100, v40
    v_and_b32 v77, v101, v41
    v_and_b32 v78, v100, v38
    v_and_b32 v79, v101, v39
    v_and_b32 v104, v128, v40
    v_and_b32 v105, v129, v41
    v_and_b32 v106, v128, v38
    v_and_b32 v107, v129, v39
    v_and_b32 v132, v156, v40
    v_and_b32 v133, v157, v41
    v_and_b32 v134, v156, v38
    v_and_b32 v135, v157, v39
    v_and_b32 v160, v184, v40
    v_and_b32 v161, v185, v41
    v_and_b32 v162, v184, v38
    v_and_b32 v163, v185, v39
    v_and_b32 v188, v212, v40
    v_and_b32 v189, v213, v41
    v_and_b32 v190, v212, v38
    v_and_b32 v191, v213, v39
    v_mfma_f32_16x16x32_bf16 v[52:55], v[60:63], v[48:51], 0
    v_mfma_f32_16x16x32_bf16 v[56:59], v[64:67], v[48:51], 0
    v_mfma_f32_16x16x32_bf16 v[80:83], v[88:91], v[76:79], 0
    v_mfma_f32_16x16x32_bf16 v[84:87], v[92:95], v[76:79], 0
    v_mfma_f32_16x16x32_bf16 v[108:111], v[116:119], v[104:107], 0
    v_mfma_f32_16x16x32_bf16 v[112:115], v[120:123], v[104:107], 0
    v_mfma_f32_16x16x32_bf16 v[136:139], v[144:147], v[132:135], 0
    v_mfma_f32_16x16x32_bf16 v[140:143], v[148:151], v[132:135], 0
    v_mfma_f32_16x16x32_bf16 v[164:167], v[172:175], v[160:163], 0
    v_mfma_f32_16x16x32_bf16 v[168:171], v[176:179], v[160:163], 0
    v_mfma_f32_16x16x32_bf16 v[192:195], v[200:203], v[188:191], 0
    v_mfma_f32_16x16x32_bf16 v[196:199], v[204:207], v[188:191], 0
    s_nop 3
    v_cvt_pk_bf16_f32 v68, v52, v53
    v_cvt_pk_bf16_f32 v69, v54, v55
    v_cvt_pk_bf16_f32 v70, v56, v57
    v_cvt_pk_bf16_f32 v71, v58, v59
    ds_write_b64 v30, v[68:69] offset:0
    v_cvt_pk_bf16_f32 v96, v80, v81
    v_cvt_pk_bf16_f32 v97, v82, v83
    v_cvt_pk_bf16_f32 v98, v84, v85
    v_cvt_pk_bf16_f32 v99, v86, v87
    ds_write_b64 v30, v[96:97] offset:392
    v_cvt_pk_bf16_f32 v124, v108, v109
    v_cvt_pk_bf16_f32 v125, v110, v111
    v_cvt_pk_bf16_f32 v126, v112, v113
    v_cvt_pk_bf16_f32 v127, v114, v115
    ds_write_b64 v30, v[124:125] offset:40
    v_cvt_pk_bf16_f32 v152, v136, v137
    v_cvt_pk_bf16_f32 v153, v138, v139
    v_cvt_pk_bf16_f32 v154, v140, v141
    v_cvt_pk_bf16_f32 v155, v142, v143
    ds_write_b64 v30, v[152:153] offset:432
    v_cvt_pk_bf16_f32 v180, v164, v165
    v_cvt_pk_bf16_f32 v181, v166, v167
    v_cvt_pk_bf16_f32 v182, v168, v169
    v_cvt_pk_bf16_f32 v183, v170, v171
    ds_write_b64 v30, v[180:181] offset:80
    v_cvt_pk_bf16_f32 v208, v192, v193
    v_cvt_pk_bf16_f32 v209, v194, v195
    v_cvt_pk_bf16_f32 v210, v196, v197
    v_cvt_pk_bf16_f32 v211, v198, v199
    ds_write_b64 v30, v[208:209] offset:472
    s_mov_b64 exec, 0xffff
    ds_write_b64 v30, v[70:71] offset:32
    ds_write_b64 v30, v[98:99] offset:424
    ds_write_b64 v30, v[126:127] offset:72
    ds_write_b64 v30, v[154:155] offset:464
    ds_write_b64 v30, v[182:183] offset:112
    ds_write_b64 v30, v[210:211] offset:504
    s_mov_b64 exec, -1
    v_lshrrev_b32 v39, 6, v25
    v_mul_u32_u24 v39, 296, v39
    v_bfe_u32 v40, v25, 4, 2
    v_add_u32 v39, v39, v40
    v_lshlrev_b32 v39, 10, v39
    v_and_b32 v40, 15, v25
    v_lshl_add_u32 v28, v40, 4, v39
    v_cmp_le_u32 vcc, 16, v24
    s_movk_i32 s61, 0x800
    v_cmp_gt_i32 s[62:63], s61, v25
    s_and_b64 vcc, vcc, s[62:63]
    v_mov_b32 v39, 0x7f000000
    v_cndmask_b32 v28, v39, v28, vcc
    s_and_b32 s60, s45, 1
    s_lshl_b32 s61, s60, 3
    v_mul_u32_u24 v29, 392, v24
    v_lshl_add_u32 v40, v3, 4, v29
    v_add_u32 v40, s61, v40
    s_cmp_eq_u32 s60, 0
    s_cselect_b32 s62, 112, 0
    v_add_u32 v29, s62, v29
    s_waitcnt lgkmcnt(0)
    ds_read2_b64 v[44:47], v40 offset0:0 offset1:1
    ds_read2_b64 v[48:51], v40 offset0:4 offset1:5
    ds_read2_b64 v[52:55], v40 offset0:8 offset1:9
    ds_read2_b64 v[56:59], v40 offset0:12 offset1:13
    ds_read_b64 v[60:61], v29
    s_mul_i32 s70, s45, 15
    s_add_u32 s70, s70, s60
    s_lshr_b32 s70, s70, 1
    s_cmp_eq_u32 s45, 10
    s_cselect_b32 s63, 5, 7
    v_add_u32 v39, 0, v3
    v_cmp_gt_u32 vcc, s63, v39
    v_add_u32 v39, s70, v39
    v_lshrrev_b32 v40, 2, v39
    v_lshl_add_u32 v30, v40, 12, v28
    v_and_b32 v39, 3, v39
    v_lshl_add_u32 v30, v39, 8, v30
    v_mov_b32 v40, 0x7f000000
    v_cndmask_b32 v30, v40, v30, vcc
    v_add_u32 v39, 2, v3
    v_cmp_gt_u32 vcc, s63, v39
    v_add_u32 v39, s70, v39
    v_lshrrev_b32 v40, 2, v39
    v_lshl_add_u32 v31, v40, 12, v28
    v_and_b32 v39, 3, v39
    v_lshl_add_u32 v31, v39, 8, v31
    v_mov_b32 v40, 0x7f000000
    v_cndmask_b32 v31, v40, v31, vcc
    v_add_u32 v39, 4, v3
    v_cmp_gt_u32 vcc, s63, v39
    v_add_u32 v39, s70, v39
    v_lshrrev_b32 v40, 2, v39
    v_lshl_add_u32 v32, v40, 12, v28
    v_and_b32 v39, 3, v39
    v_lshl_add_u32 v32, v39, 8, v32
    v_mov_b32 v40, 0x7f000000
    v_cndmask_b32 v32, v40, v32, vcc
    v_add_u32 v39, 6, v3
    v_cmp_gt_u32 vcc, s63, v39
    v_add_u32 v39, s70, v39
    v_lshrrev_b32 v40, 2, v39
    v_lshl_add_u32 v33, v40, 12, v28
    v_and_b32 v39, 3, v39
    v_lshl_add_u32 v33, v39, 8, v33
    v_mov_b32 v40, 0x7f000000
    v_cndmask_b32 v33, v40, v33, vcc
    s_lshl_b32 s62, s60, 3
    s_sub_u32 s62, 7, s62
    s_add_u32 s62, s62, s70
    v_mov_b32 v39, s62
    s_sub_u32 s63, s63, 6
    v_cmp_gt_i32 vcc, s63, v3
    v_lshrrev_b32 v40, 2, v39
    v_lshl_add_u32 v34, v40, 12, v28
    v_and_b32 v39, 3, v39
    v_lshl_add_u32 v34, v39, 8, v34
    v_mov_b32 v40, 0x7f000000
    v_cndmask_b32 v34, v40, v34, vcc
    s_waitcnt lgkmcnt(0)
    buffer_store_dwordx4 v[44:47], v30, s[20:23], 0 offen sc1
    buffer_store_dwordx4 v[48:51], v31, s[20:23], 0 offen sc1
    buffer_store_dwordx4 v[52:55], v32, s[20:23], 0 offen sc1
    buffer_store_dwordx4 v[56:59], v33, s[20:23], 0 offen sc1
    buffer_store_dwordx2 v[60:61], v34, s[20:23], s61 offen sc1
    s_add_u32 s61, s46, 16
    s_add_u32 s62, s46, 255
    s_min_u32 s62, s62, 0x7ff
    s_lshr_b32 s61, s61, 6
    s_lshr_b32 s62, s62, 6
    s_sub_u32 s62, s62, s61
    s_add_u32 s62, s62, 1
    s_lshl_b32 s61, s61, 3
    s_lshl_b32 s62, s62, 3
    s_mov_b32 s63, 13599236
    s_branch P1_DONE
K1_SPARE:
    s_mov_b32 s45, s61
    s_waitcnt lgkmcnt(0)
    s_mov_b32 s12, s28
    s_and_b32 s13, s29, 0xffff
    s_mov_b32 s14, 819200
    s_mov_b32 s15, 0x00020000
    s_mov_b32 s20, s6
    s_and_b32 s21, s7, 0xffff
    s_mov_b32 s22, 13632000
    s_mov_b32 s23, 0x00020000
    s_cmp_lt_u32 s40, 4
    s_mov_b32 s8, s24
    s_and_b32 s9, s25, 0xffff
    s_mov_b32 s10, 2621440
    s_mov_b32 s11, 0x00020000
    s_mov_b32 s76, s4
    s_and_b32 s77, s5, 0xffff
    s_mov_b32 s78, 256
    s_mov_b32 s79, 0x00020000
    s_mov_b32 s73, 0
    s_cmp_lt_u32 s40, 4
    s_cbranch_scc1 K1_SP_NOPF
    s_mul_i32 s60, s2, 171
    s_lshr_b32 s60, s60, 9
    s_mul_i32 s61, s60, 3
    s_sub_u32 s61, s2, s61
    s_mul_i32 s73, s61, 5504
    s_lshl_b32 s62, s60, 6
    s_add_u32 s73, s73, s62
    s_lshl_b32 s73, s73, 2
    s_add_u32 s73, s73, 13516800
    s_movk_i32 s62, 3456
    s_mov_b32 s78, 2211840
    s_cmp_lt_u32 s60, 27
    s_cselect_b32 s76, s32, s34
    s_cselect_b32 s77, s33, s35
    s_cselect_b32 s63, 0, 27
    s_cmp_lt_u32 s60, 54
    s_cselect_b32 s76, s76, s26
    s_cselect_b32 s77, s77, s27
    s_cselect_b32 s63, s63, 54
    s_cselect_b32 s62, s62, 3840
    s_cselect_b32 s78, s78, 2457600
    s_and_b32 s77, s77, 0xffff
    s_mov_b32 s79, 0x00020000
    s_sub_u32 s60, s60, s63
    s_lshl_b32 s60, s60, 7
    s_mul_i32 s61, s61, 224
    s_lshl_b32 s63, s40, 3
    s_add_u32 s61, s61, s63
    s_sub_u32 s61, s61, 32
    v_lshrrev_b32 v64, 3, v1
    v_add_u32 v64, s61, v64
    v_mul_lo_u32 v64, v64, s62
    v_and_b32 v65, 7, v1
    v_lshl_add_u32 v64, v65, 4, v64
    s_lshl_b32 s62, s62, 5
    buffer_load_dwordx4 v[24:27], v64, s[76:79], s60 offen
    s_add_u32 s60, s60, s62
    buffer_load_dwordx4 v[28:31], v64, s[76:79], s60 offen
    s_add_u32 s60, s60, s62
    buffer_load_dwordx4 v[32:35], v64, s[76:79], s60 offen
    s_add_u32 s60, s60, s62
    buffer_load_dwordx4 v[36:39], v64, s[76:79], s60 offen
    s_add_u32 s60, s60, s62
    buffer_load_dwordx4 v[40:43], v64, s[76:79], s60 offen
    s_add_u32 s60, s60, s62
    buffer_load_dwordx4 v[44:47], v64, s[76:79], s60 offen
    s_add_u32 s60, s60, s62
    buffer_load_dwordx4 v[48:51], v64, s[76:79], s60 offen
    s_lshl_b32 s60, s2, 2
    s_add_u32 s60, s60, s40
    s_sub_u32 s60, s60, 4
    s_mul_i32 s60, s60, 2560
    v_mul_u32_u24 v65, 1280, v3
    v_lshl_add_u32 v65, v2, 4, v65
    v_lshrrev_b32 v66, 4, v2
    v_lshl_add_u32 v66, v66, 30, v65
    buffer_load_dwordx4 v[52:55], v65, s[8:11], s60 offen
    buffer_load_dwordx4 v[56:59], v65, s[8:11], s60 offen offset:512
    buffer_load_dwordx4 v[60:63], v66, s[8:11], s60 offen offset:1024
    s_and_b32 s60, s2, 7
    s_lshr_b32 s61, s2, 3
    s_and_b32 s62, s60, 1
    s_lshr_b32 s63, s60, 1
    s_cmp_eq_u32 s40, 4
    s_cbranch_scc0 K1_PF_W1
    s_mov_b32 s16, s24
    s_and_b32 s17, s25, 0xffff
    s_mov_b32 s18, 2621440
    s_mov_b32 s19, 0x00020000
    s_lshl_b32 s62, s62, 10
    s_mul_i32 s61, s61, 40
    s_add_u32 s61, s61, s62
    v_add_u32 v64, s61, v1
    v_mul_u32_u24 v83, 1280, v64
    v_cmp_gt_u32 vcc, 40, v1
    s_movk_i32 s75, 128
    s_movk_i32 s52, 256
    s_branch K1_PF_E1
K1_PF_W1:
    s_cmp_eq_u32 s40, 7
    s_cbranch_scc1 K1_PF_Q1
    s_cmp_eq_u32 s40, 5
    s_cselect_b32 s16, s32, s34
    s_cselect_b32 s17, s33, s35
    s_mov_b32 s16, s16
    s_and_b32 s17, s17, 0xffff
    s_mov_b32 s18, 2211840
    s_mov_b32 s19, 0x00020000
    s_mul_i32 s63, s63, 18
    s_lshr_b32 s63, s63, 2
    s_mul_i32 s63, s63, 192
    s_mul_i32 s61, s61, 6912
    s_add_u32 s61, s61, s63
    v_lshrrev_b32 v64, 4, v1
    v_and_b32 v65, 15, v1
    v_mul_u32_u24 v66, 3456, v64
    v_lshl_add_u32 v66, v65, 7, v66
    v_add_u32 v83, s61, v66
    v_lshl_add_u32 v64, v64, 3, v65
    v_cmp_gt_u32 vcc, 8, v65
    v_cmp_gt_u32 s[62:63], 32, v1
    s_and_b64 vcc, vcc, s[62:63]
    s_mov_b32 s75, 221184
    s_mov_b32 s52, 442368
    s_branch K1_PF_E1
K1_PF_Q1:
    s_mov_b32 s16, s26
    s_and_b32 s17, s27, 0xffff
    s_mov_b32 s18, 2457600
    s_mov_b32 s19, 0x00020000
    s_mul_i32 s63, s63, 14
    s_mul_i32 s60, s63, 205
    s_lshr_b32 s60, s60, 10
    s_lshr_b32 s63, s63, 2
    s_cmp_eq_u32 s62, 0
    s_cselect_b32 s63, s60, s63
    s_mul_i32 s63, s63, 120
    s_mul_i32 s61, s61, 7680
    s_add_u32 s61, s61, s63
    v_lshrrev_b32 v64, 3, v1
    v_and_b32 v65, 7, v1
    v_mul_u32_u24 v66, 1280, v64
    v_lshl_add_u32 v66, v65, 7, v66
    v_add_u32 v83, s61, v66
    v_cmp_gt_u32 vcc, 5, v65
    v_cmp_gt_u32 s[62:63], 48, v1
    s_and_b64 vcc, vcc, s[62:63]
    s_mov_b32 s75, 245760
    s_mov_b32 s52, 491520
K1_PF_E1:
    v_mov_b32 v64, 0x7f000000
    v_cndmask_b32 v83, v64, v83, vcc
    s_lshl_b32 s60, s40, 8
    s_add_u32 s60, s60, 159040
    s_mov_b32 s66, 0x3f803f80
    v_mov_b32 v14, 0
    v_mov_b32 v15, 0
    v_mov_b32 v16, 0
    v_mov_b32 v17, 0
    s_waitcnt vmcnt(0)
    v_lshlrev_b32 v64, 16, v24
    v_and_b32 v65, 0xffff0000, v24
    v_lshlrev_b32 v66, 16, v25
    v_and_b32 v67, 0xffff0000, v25
    v_lshlrev_b32 v68, 16, v26
    v_and_b32 v69, 0xffff0000, v26
    v_lshlrev_b32 v70, 16, v27
    v_and_b32 v71, 0xffff0000, v27
    v_lshlrev_b32 v19, 16, v28
    v_and_b32 v28, 0xffff0000, v28
    v_add_f32 v64, v64, v19
    v_add_f32 v65, v65, v28
    v_lshlrev_b32 v19, 16, v29
    v_and_b32 v29, 0xffff0000, v29
    v_add_f32 v66, v66, v19
    v_add_f32 v67, v67, v29
    v_lshlrev_b32 v19, 16, v30
    v_and_b32 v30, 0xffff0000, v30
    v_add_f32 v68, v68, v19
    v_add_f32 v69, v69, v30
    v_lshlrev_b32 v19, 16, v31
    v_and_b32 v31, 0xffff0000, v31
    v_add_f32 v70, v70, v19
    v_add_f32 v71, v71, v31
    v_lshlrev_b32 v19, 16, v32
    v_and_b32 v32, 0xffff0000, v32
    v_add_f32 v64, v64, v19
    v_add_f32 v65, v65, v32
    v_lshlrev_b32 v19, 16, v33
    v_and_b32 v33, 0xffff0000, v33
    v_add_f32 v66, v66, v19
    v_add_f32 v67, v67, v33
    v_lshlrev_b32 v19, 16, v34
    v_and_b32 v34, 0xffff0000, v34
    v_add_f32 v68, v68, v19
    v_add_f32 v69, v69, v34
    v_lshlrev_b32 v19, 16, v35
    v_and_b32 v35, 0xffff0000, v35
    v_add_f32 v70, v70, v19
    v_add_f32 v71, v71, v35
    v_lshlrev_b32 v19, 16, v36
    v_and_b32 v36, 0xffff0000, v36
    v_add_f32 v64, v64, v19
    v_add_f32 v65, v65, v36
    v_lshlrev_b32 v19, 16, v37
    v_and_b32 v37, 0xffff0000, v37
    v_add_f32 v66, v66, v19
    v_add_f32 v67, v67, v37
    v_lshlrev_b32 v19, 16, v38
    v_and_b32 v38, 0xffff0000, v38
    v_add_f32 v68, v68, v19
    v_add_f32 v69, v69, v38
    v_lshlrev_b32 v19, 16, v39
    v_and_b32 v39, 0xffff0000, v39
    v_add_f32 v70, v70, v19
    v_add_f32 v71, v71, v39
    v_lshlrev_b32 v19, 16, v40
    v_and_b32 v40, 0xffff0000, v40
    v_add_f32 v64, v64, v19
    v_add_f32 v65, v65, v40
    v_lshlrev_b32 v19, 16, v41
    v_and_b32 v41, 0xffff0000, v41
    v_add_f32 v66, v66, v19
    v_add_f32 v67, v67, v41
    v_lshlrev_b32 v19, 16, v42
    v_and_b32 v42, 0xffff0000, v42
    v_add_f32 v68, v68, v19
    v_add_f32 v69, v69, v42
    v_lshlrev_b32 v19, 16, v43
    v_and_b32 v43, 0xffff0000, v43
    v_add_f32 v70, v70, v19
    v_add_f32 v71, v71, v43
    v_lshlrev_b32 v19, 16, v44
    v_and_b32 v44, 0xffff0000, v44
    v_add_f32 v64, v64, v19
    v_add_f32 v65, v65, v44
    v_lshlrev_b32 v19, 16, v45
    v_and_b32 v45, 0xffff0000, v45
    v_add_f32 v66, v66, v19
    v_add_f32 v67, v67, v45
    v_lshlrev_b32 v19, 16, v46
    v_and_b32 v46, 0xffff0000, v46
    v_add_f32 v68, v68, v19
    v_add_f32 v69, v69, v46
    v_lshlrev_b32 v19, 16, v47
    v_and_b32 v47, 0xffff0000, v47
    v_add_f32 v70, v70, v19
    v_add_f32 v71, v71, v47
    v_lshlrev_b32 v19, 16, v48
    v_and_b32 v48, 0xffff0000, v48
    v_add_f32 v64, v64, v19
    v_add_f32 v65, v65, v48
    v_lshlrev_b32 v19, 16, v49
    v_and_b32 v49, 0xffff0000, v49
    v_add_f32 v66, v66, v19
    v_add_f32 v67, v67, v49
    v_lshlrev_b32 v19, 16, v50
    v_and_b32 v50, 0xffff0000, v50
    v_add_f32 v68, v68, v19
    v_add_f32 v69, v69, v50
    v_lshlrev_b32 v19, 16, v51
    v_and_b32 v51, 0xffff0000, v51
    v_add_f32 v70, v70, v19
    v_add_f32 v71, v71, v51
    v_and_b32 v19, 7, v1
    v_lshl_add_u32 v18, v19, 5, s60
    v_lshrrev_b32 v19, 4, v1
    v_lshl_add_u32 v18, v19, 3, v18
    v_permlane32_swap_b32 v64, v68
    v_permlane32_swap_b32 v65, v69
    v_permlane32_swap_b32 v66, v70
    v_permlane32_swap_b32 v67, v71
    s_nop 1
    v_add_f32 v64, v64, v68
    v_add_f32 v65, v65, v69
    v_add_f32 v66, v66, v70
    v_add_f32 v67, v67, v71
    s_nop 1
    v_permlane16_swap_b32 v64, v66
    v_permlane16_swap_b32 v65, v67
    s_nop 1
    v_add_f32 v64, v64, v66
    v_add_f32 v65, v65, v67
    s_nop 1
    v_add_f32_dpp v64, v64, v64 row_ror:8 row_mask:0xf bank_mask:0xf
    v_add_f32_dpp v65, v65, v65 row_ror:8 row_mask:0xf bank_mask:0xf
    ds_write_b64 v18, v[64:65]
    v_dot2c_f32_bf16 v14, s66, v52
    v_dot2c_f32_bf16 v16, v52, v52
    v_dot2c_f32_bf16 v15, s66, v53
    v_dot2c_f32_bf16 v17, v53, v53
    v_dot2c_f32_bf16 v14, s66, v54
    v_dot2c_f32_bf16 v16, v54, v54
    v_dot2c_f32_bf16 v15, s66, v55
    v_dot2c_f32_bf16 v17, v55, v55
    v_dot2c_f32_bf16 v14, s66, v56
    v_dot2c_f32_bf16 v16, v56, v56
    v_dot2c_f32_bf16 v15, s66, v57
    v_dot2c_f32_bf16 v17, v57, v57
    v_dot2c_f32_bf16 v14, s66, v58
    v_dot2c_f32_bf16 v16, v58, v58
    v_dot2c_f32_bf16 v15, s66, v59
    v_dot2c_f32_bf16 v17, v59, v59
    v_dot2c_f32_bf16 v14, s66, v60
    v_dot2c_f32_bf16 v16, v60, v60
    v_dot2c_f32_bf16 v15, s66, v61
    v_dot2c_f32_bf16 v17, v61, v61
    v_dot2c_f32_bf16 v14, s66, v62
    v_dot2c_f32_bf16 v16, v62, v62
    v_dot2c_f32_bf16 v15, s66, v63
    v_dot2c_f32_bf16 v17, v63, v63
    s_nop 2
    v_add_f32 v14, v14, v15
    v_add_f32 v16, v16, v17
    s_nop 1
    v_add_f32_dpp v14, v14, v14 quad_perm:[1,0,3,2] row_mask:0xf bank_mask:0xf
    v_add_f32_dpp v16, v16, v16 quad_perm:[1,0,3,2] row_mask:0xf bank_mask:0xf
    s_nop 1
    v_add_f32_dpp v14, v14, v14 quad_perm:[2,3,0,1] row_mask:0xf bank_mask:0xf
    v_add_f32_dpp v16, v16, v16 quad_perm:[2,3,0,1] row_mask:0xf bank_mask:0xf
    s_nop 1
    v_add_f32_dpp v14, v14, v14 row_half_mirror row_mask:0xf bank_mask:0xf
    v_add_f32_dpp v16, v16, v16 row_half_mirror row_mask:0xf bank_mask:0xf
    s_nop 1
    v_add_f32_dpp v14, v14, v14 row_mirror row_mask:0xf bank_mask:0xf
    v_add_f32_dpp v16, v16, v16 row_mirror row_mask:0xf bank_mask:0xf
    v_mov_b32 v15, v14
    v_mov_b32 v17, v16
    s_nop 1
    v_permlane16_swap_b32 v14, v15
    v_permlane16_swap_b32 v16, v17
    s_nop 1
    v_add_f32 v14, v14, v15
    v_add_f32 v16, v16, v17
    v_mul_f32 v14, 0x3acccccd, v14
    v_mul_f32 v16, 0x3acccccd, v16
    v_fma_f32 v16, -v14, v14, v16
    v_max_f32 v16, 0, v16
    v_cvt_pk_bf16_f32 v14, v14, v14
    v_cvt_pk_bf16_f32 v16, v16, v16
    v_and_b32 v16, 0xffff0000, v16
    v_add_f32 v16, 0x3727c5ac, v16
    v_cvt_pk_bf16_f32 v16, v16, v16
    v_and_b32 v16, 0xffff0000, v16
    v_sqrt_f32 v16, v16
    s_lshl_b32 s60, s40, 4
    s_add_u32 s60, s60, 161024
    v_cvt_pk_bf16_f32 v16, v16, v16
    v_and_b32 v15, 0xffff0000, v16
    v_lshl_add_u32 v18, v3, 3, s60
    ds_write_b64 v18, v[14:15]
    s_waitcnt lgkmcnt(0)
K1_SP_NOPF:
    s_barrier
    s_cmp_eq_u32 s40, 4
    s_cbranch_scc0 K1_SP_NOPUB
    v_lshlrev_b32 v24, 2, v1
    v_add_u32 v25, 160064, v24
    ds_read_b32 v26, v25 offset:0
    ds_read_b32 v27, v25 offset:256
    ds_read_b32 v28, v25 offset:512
    ds_read_b32 v29, v25 offset:768
    ds_read_b32 v30, v25 offset:1024
    v_lshrrev_b32 v31, 4, v1
    v_min_u32 v31, 1, v31
    v_lshl_add_u32 v31, v31, 30, v24
    s_lshl_b32 s60, s2, 6
    s_add_u32 s60, s60, 13582848
    s_waitcnt lgkmcnt(0)
    v_add_f32 v26, v26, v27
    v_add_f32 v28, v28, v29
    v_add_f32 v26, v26, v28
    buffer_store_dword v26, v24, s[20:23], s73 offen sc1
    buffer_store_dword v30, v31, s[20:23], s60 offen sc1
    s_lshl_b32 s60, s2, 7
    s_add_u32 s60, s60, 13599232
    v_mov_b32 v27, 0
    buffer_store_dword v27, v31, s[20:23], s60 offen sc1
    s_and_b32 s61, s2, 7
    s_mov_b32 s76, s4
    s_and_b32 s77, s5, 0xffff
    s_mov_b32 s78, 256
    s_mov_b32 s79, 0x00020000
    s_lshl_b32 s60, s61, 2
    v_mov_b32 v32, 0
    v_mov_b32 v33, 1
    s_waitcnt vmcnt(0)
    s_mov_b64 exec, 1
    buffer_atomic_add v33, v32, s[76:79], s60 offen sc1
    s_mov_b64 exec, -1
K1_SP_NOPUB:
    s_mov_b32 s16, s36
    s_and_b32 s17, s37, 0xffff
    s_mov_b32 s18, 2211840
    s_mov_b32 s19, 0x00020000
    s_mul_i32 s60, s40, 320
    s_mov_b32 s61, 52429
    s_movk_i32 s62, 1280
    v_add_u32 v64, s60, v1
    v_mul_lo_u32 v65, v64, s61
    v_lshrrev_b32 v65, 22, v65
    v_mul_u32_u24 v66, 80, v65
    v_sub_u32 v64, v64, v66
    v_and_b32 v66, 3, v65
    v_bfe_u32 v67, v65, 3, 1
    v_lshl_add_u32 v66, v67, 2, v66
    v_lshlrev_b32 v66, 1, v66
    v_xor_b32 v64, v64, v66
    v_mul_lo_u32 v65, v65, s62
    v_lshl_add_u32 v4, v64, 4, v65
    v_add_u32 v64, s60, v1
    v_add_u32 v64, 64, v64
    v_mul_lo_u32 v65, v64, s61
    v_lshrrev_b32 v65, 22, v65
    v_mul_u32_u24 v66, 80, v65
    v_sub_u32 v64, v64, v66
    v_and_b32 v66, 3, v65
    v_bfe_u32 v67, v65, 3, 1
    v_lshl_add_u32 v66, v67, 2, v66
    v_lshlrev_b32 v66, 1, v66
    v_xor_b32 v64, v64, v66
    v_mul_lo_u32 v65, v65, s62
    v_lshl_add_u32 v5, v64, 4, v65
    v_add_u32 v64, s60, v1
    v_add_u32 v64, 128, v64
    v_mul_lo_u32 v65, v64, s61
    v_lshrrev_b32 v65, 22, v65
    v_mul_u32_u24 v66, 80, v65
    v_sub_u32 v64, v64, v66
    v_and_b32 v66, 3, v65
    v_bfe_u32 v67, v65, 3, 1
    v_lshl_add_u32 v66, v67, 2, v66
    v_lshlrev_b32 v66, 1, v66
    v_xor_b32 v64, v64, v66
    v_mul_lo_u32 v65, v65, s62
    v_lshl_add_u32 v6, v64, 4, v65
    v_add_u32 v64, s60, v1
    v_add_u32 v64, 192, v64
    v_mul_lo_u32 v65, v64, s61
    v_lshrrev_b32 v65, 22, v65
    v_mul_u32_u24 v66, 80, v65
    v_sub_u32 v64, v64, v66
    v_and_b32 v66, 3, v65
    v_bfe_u32 v67, v65, 3, 1
    v_lshl_add_u32 v66, v67, 2, v66
    v_lshlrev_b32 v66, 1, v66
    v_xor_b32 v64, v64, v66
    v_mul_lo_u32 v65, v65, s62
    v_lshl_add_u32 v7, v64, 4, v65
    v_add_u32 v64, s60, v1
    v_add_u32 v64, 256, v64
    v_mul_lo_u32 v65, v64, s61
    v_lshrrev_b32 v65, 22, v65
    v_mul_u32_u24 v66, 80, v65
    v_sub_u32 v64, v64, v66
    v_and_b32 v66, 3, v65
    v_bfe_u32 v67, v65, 3, 1
    v_lshl_add_u32 v66, v67, 2, v66
    v_lshlrev_b32 v66, 1, v66
    v_xor_b32 v64, v64, v66
    v_mul_lo_u32 v65, v65, s62
    v_lshl_add_u32 v8, v64, 4, v65
    v_lshrrev_b32 v64, 4, v1
    v_bfe_u32 v65, v1, 2, 2
    v_lshl_add_u32 v66, v64, 3, v65
    v_mul_lo_u32 v66, v66, s62
    v_and_b32 v67, 3, v1
    v_lshl_add_u32 v10, v67, 3, v66
    v_and_b32 v64, 1, v64
    v_lshl_add_u32 v64, v64, 2, v65
    v_lshlrev_b32 v11, 5, v64
    v_lshlrev_b32 v12, 4, v1
    s_mov_b32 s51, 0
K1_SP_ROUND:
    s_mul_i32 s46, s51, 39
    s_add_u32 s46, s46, s45
    s_add_u32 s46, s46, 0
    s_cmp_lt_u32 s46, 74
    s_cbranch_scc0 K1_SP_NOLD0
    s_mul_i32 s55, s40, 5120
    s_add_u32 s55, s55, 0
    s_cmp_lt_u32 s46, 20
    s_cbranch_scc0 K1_SP_DN0
    s_mul_i32 s52, s46, 40960
    s_add_u32 m0, s55, 0
    s_nop 0
    buffer_load_dwordx4 v4, s[12:15], s52 offen lds
    s_add_u32 m0, s55, 1024
    s_nop 0
    buffer_load_dwordx4 v5, s[12:15], s52 offen lds
    s_add_u32 m0, s55, 2048
    s_nop 0
    buffer_load_dwordx4 v6, s[12:15], s52 offen lds
    s_add_u32 m0, s55, 3072
    s_nop 0
    buffer_load_dwordx4 v7, s[12:15], s52 offen lds
    s_add_u32 m0, s55, 4096
    s_nop 0
    buffer_load_dwordx4 v8, s[12:15], s52 offen lds
    s_branch K1_SP_NOLD0
K1_SP_DN0:
    s_sub_u32 s52, s46, 20
    s_mul_i32 s52, s52, 40960
    s_add_u32 m0, s55, 0
    s_nop 0
    buffer_load_dwordx4 v4, s[16:19], s52 offen lds
    s_add_u32 m0, s55, 1024
    s_nop 0
    buffer_load_dwordx4 v5, s[16:19], s52 offen lds
    s_add_u32 m0, s55, 2048
    s_nop 0
    buffer_load_dwordx4 v6, s[16:19], s52 offen lds
    s_add_u32 m0, s55, 3072
    s_nop 0
    buffer_load_dwordx4 v7, s[16:19], s52 offen lds
    s_add_u32 m0, s55, 4096
    s_nop 0
    buffer_load_dwordx4 v8, s[16:19], s52 offen lds
K1_SP_NOLD0:
    s_mul_i32 s46, s51, 39
    s_add_u32 s46, s46, s45
    s_add_u32 s46, s46, 13
    s_cmp_lt_u32 s46, 74
    s_cbranch_scc0 K1_SP_NOLD1
    s_mul_i32 s55, s40, 5120
    s_add_u32 s55, s55, 40960
    s_cmp_lt_u32 s46, 20
    s_cbranch_scc0 K1_SP_DN1
    s_mul_i32 s52, s46, 40960
    s_add_u32 m0, s55, 0
    s_nop 0
    buffer_load_dwordx4 v4, s[12:15], s52 offen lds
    s_add_u32 m0, s55, 1024
    s_nop 0
    buffer_load_dwordx4 v5, s[12:15], s52 offen lds
    s_add_u32 m0, s55, 2048
    s_nop 0
    buffer_load_dwordx4 v6, s[12:15], s52 offen lds
    s_add_u32 m0, s55, 3072
    s_nop 0
    buffer_load_dwordx4 v7, s[12:15], s52 offen lds
    s_add_u32 m0, s55, 4096
    s_nop 0
    buffer_load_dwordx4 v8, s[12:15], s52 offen lds
    s_branch K1_SP_NOLD1
K1_SP_DN1:
    s_sub_u32 s52, s46, 20
    s_mul_i32 s52, s52, 40960
    s_add_u32 m0, s55, 0
    s_nop 0
    buffer_load_dwordx4 v4, s[16:19], s52 offen lds
    s_add_u32 m0, s55, 1024
    s_nop 0
    buffer_load_dwordx4 v5, s[16:19], s52 offen lds
    s_add_u32 m0, s55, 2048
    s_nop 0
    buffer_load_dwordx4 v6, s[16:19], s52 offen lds
    s_add_u32 m0, s55, 3072
    s_nop 0
    buffer_load_dwordx4 v7, s[16:19], s52 offen lds
    s_add_u32 m0, s55, 4096
    s_nop 0
    buffer_load_dwordx4 v8, s[16:19], s52 offen lds
K1_SP_NOLD1:
    s_mul_i32 s46, s51, 39
    s_add_u32 s46, s46, s45
    s_add_u32 s46, s46, 26
    s_cmp_lt_u32 s46, 74
    s_cbranch_scc0 K1_SP_NOLD2
    s_mul_i32 s55, s40, 5120
    s_add_u32 s55, s55, 81920
    s_cmp_lt_u32 s46, 20
    s_cbranch_scc0 K1_SP_DN2
    s_mul_i32 s52, s46, 40960
    s_add_u32 m0, s55, 0
    s_nop 0
    buffer_load_dwordx4 v4, s[12:15], s52 offen lds
    s_add_u32 m0, s55, 1024
    s_nop 0
    buffer_load_dwordx4 v5, s[12:15], s52 offen lds
    s_add_u32 m0, s55, 2048
    s_nop 0
    buffer_load_dwordx4 v6, s[12:15], s52 offen lds
    s_add_u32 m0, s55, 3072
    s_nop 0
    buffer_load_dwordx4 v7, s[12:15], s52 offen lds
    s_add_u32 m0, s55, 4096
    s_nop 0
    buffer_load_dwordx4 v8, s[12:15], s52 offen lds
    s_branch K1_SP_NOLD2
K1_SP_DN2:
    s_sub_u32 s52, s46, 20
    s_mul_i32 s52, s52, 40960
    s_add_u32 m0, s55, 0
    s_nop 0
    buffer_load_dwordx4 v4, s[16:19], s52 offen lds
    s_add_u32 m0, s55, 1024
    s_nop 0
    buffer_load_dwordx4 v5, s[16:19], s52 offen lds
    s_add_u32 m0, s55, 2048
    s_nop 0
    buffer_load_dwordx4 v6, s[16:19], s52 offen lds
    s_add_u32 m0, s55, 3072
    s_nop 0
    buffer_load_dwordx4 v7, s[16:19], s52 offen lds
    s_add_u32 m0, s55, 4096
    s_nop 0
    buffer_load_dwordx4 v8, s[16:19], s52 offen lds
K1_SP_NOLD2:
    s_waitcnt vmcnt(0)
    s_barrier
    s_mul_i32 s46, s51, 39
    s_add_u32 s46, s46, s45
    s_add_u32 s46, s46, 0
    s_cmp_lt_u32 s46, 74
    s_cbranch_scc0 K1_SP_NOST0
    s_mul_i32 s60, s40, 160
    s_add_u32 s61, s60, 0
    v_xad_u32 v13, v11, s61, v10
    ds_read_b64_tr_b16 v[24:25], v13 offset:0
    ds_read_b64_tr_b16 v[26:27], v13 offset:5120
    s_add_u32 s61, s60, 32
    v_xad_u32 v13, v11, s61, v10
    ds_read_b64_tr_b16 v[28:29], v13 offset:0
    ds_read_b64_tr_b16 v[30:31], v13 offset:5120
    s_add_u32 s61, s60, 64
    v_xad_u32 v13, v11, s61, v10
    ds_read_b64_tr_b16 v[32:33], v13 offset:0
    ds_read_b64_tr_b16 v[34:35], v13 offset:5120
    s_add_u32 s61, s60, 96
    v_xad_u32 v13, v11, s61, v10
    ds_read_b64_tr_b16 v[36:37], v13 offset:0
    ds_read_b64_tr_b16 v[38:39], v13 offset:5120
    s_add_u32 s61, s60, 128
    v_xad_u32 v13, v11, s61, v10
    ds_read_b64_tr_b16 v[40:41], v13 offset:0
    ds_read_b64_tr_b16 v[42:43], v13 offset:5120
    s_mul_i32 s60, s40, 74
    s_add_u32 s60, s60, s46
    s_mul_i32 s60, s60, 5120
    s_add_u32 s60, s60, 10485760
    s_add_u32 s61, s60, 4096
    s_waitcnt lgkmcnt(0)
    buffer_store_dwordx4 v[24:27], v12, s[20:23], s60 offen offset:0 sc1
    buffer_store_dwordx4 v[28:31], v12, s[20:23], s60 offen offset:1024 sc1
    buffer_store_dwordx4 v[32:35], v12, s[20:23], s60 offen offset:2048 sc1
    buffer_store_dwordx4 v[36:39], v12, s[20:23], s60 offen offset:3072 sc1
    buffer_store_dwordx4 v[40:43], v12, s[20:23], s61 offen sc1
    s_nop 1
K1_SP_NOST0:
    s_mul_i32 s46, s51, 39
    s_add_u32 s46, s46, s45
    s_add_u32 s46, s46, 13
    s_cmp_lt_u32 s46, 74
    s_cbranch_scc0 K1_SP_NOST1
    s_mul_i32 s60, s40, 160
    s_add_u32 s61, s60, 0
    v_xad_u32 v13, v11, s61, v10
    ds_read_b64_tr_b16 v[24:25], v13 offset:40960
    ds_read_b64_tr_b16 v[26:27], v13 offset:46080
    s_add_u32 s61, s60, 32
    v_xad_u32 v13, v11, s61, v10
    ds_read_b64_tr_b16 v[28:29], v13 offset:40960
    ds_read_b64_tr_b16 v[30:31], v13 offset:46080
    s_add_u32 s61, s60, 64
    v_xad_u32 v13, v11, s61, v10
    ds_read_b64_tr_b16 v[32:33], v13 offset:40960
    ds_read_b64_tr_b16 v[34:35], v13 offset:46080
    s_add_u32 s61, s60, 96
    v_xad_u32 v13, v11, s61, v10
    ds_read_b64_tr_b16 v[36:37], v13 offset:40960
    ds_read_b64_tr_b16 v[38:39], v13 offset:46080
    s_add_u32 s61, s60, 128
    v_xad_u32 v13, v11, s61, v10
    ds_read_b64_tr_b16 v[40:41], v13 offset:40960
    ds_read_b64_tr_b16 v[42:43], v13 offset:46080
    s_mul_i32 s60, s40, 74
    s_add_u32 s60, s60, s46
    s_mul_i32 s60, s60, 5120
    s_add_u32 s60, s60, 10485760
    s_add_u32 s61, s60, 4096
    s_waitcnt lgkmcnt(0)
    buffer_store_dwordx4 v[24:27], v12, s[20:23], s60 offen offset:0 sc1
    buffer_store_dwordx4 v[28:31], v12, s[20:23], s60 offen offset:1024 sc1
    buffer_store_dwordx4 v[32:35], v12, s[20:23], s60 offen offset:2048 sc1
    buffer_store_dwordx4 v[36:39], v12, s[20:23], s60 offen offset:3072 sc1
    buffer_store_dwordx4 v[40:43], v12, s[20:23], s61 offen sc1
    s_nop 1
K1_SP_NOST1:
    s_mul_i32 s46, s51, 39
    s_add_u32 s46, s46, s45
    s_add_u32 s46, s46, 26
    s_cmp_lt_u32 s46, 74
    s_cbranch_scc0 K1_SP_NOST2
    s_mul_i32 s60, s40, 160
    s_add_u32 s61, s60, 0
    v_xad_u32 v13, v11, s61, v10
    v_add_u32 v13, 40960, v13
    ds_read_b64_tr_b16 v[24:25], v13 offset:40960
    ds_read_b64_tr_b16 v[26:27], v13 offset:46080
    s_add_u32 s61, s60, 32
    v_xad_u32 v13, v11, s61, v10
    v_add_u32 v13, 40960, v13
    ds_read_b64_tr_b16 v[28:29], v13 offset:40960
    ds_read_b64_tr_b16 v[30:31], v13 offset:46080
    s_add_u32 s61, s60, 64
    v_xad_u32 v13, v11, s61, v10
    v_add_u32 v13, 40960, v13
    ds_read_b64_tr_b16 v[32:33], v13 offset:40960
    ds_read_b64_tr_b16 v[34:35], v13 offset:46080
    s_add_u32 s61, s60, 96
    v_xad_u32 v13, v11, s61, v10
    v_add_u32 v13, 40960, v13
    ds_read_b64_tr_b16 v[36:37], v13 offset:40960
    ds_read_b64_tr_b16 v[38:39], v13 offset:46080
    s_add_u32 s61, s60, 128
    v_xad_u32 v13, v11, s61, v10
    v_add_u32 v13, 40960, v13
    ds_read_b64_tr_b16 v[40:41], v13 offset:40960
    ds_read_b64_tr_b16 v[42:43], v13 offset:46080
    s_mul_i32 s60, s40, 74
    s_add_u32 s60, s60, s46
    s_mul_i32 s60, s60, 5120
    s_add_u32 s60, s60, 10485760
    s_add_u32 s61, s60, 4096
    s_waitcnt lgkmcnt(0)
    buffer_store_dwordx4 v[24:27], v12, s[20:23], s60 offen offset:0 sc1
    buffer_store_dwordx4 v[28:31], v12, s[20:23], s60 offen offset:1024 sc1
    buffer_store_dwordx4 v[32:35], v12, s[20:23], s60 offen offset:2048 sc1
    buffer_store_dwordx4 v[36:39], v12, s[20:23], s60 offen offset:3072 sc1
    buffer_store_dwordx4 v[40:43], v12, s[20:23], s61 offen sc1
    s_nop 1
K1_SP_NOST2:
    s_waitcnt vmcnt(0)
    s_barrier
    s_add_u32 s51, s51, 1
    s_cmp_lt_u32 s51, 2
    s_cbranch_scc1 K1_SP_ROUND
    s_mov_b32 s76, s4
    s_and_b32 s77, s5, 0xffff
    s_mov_b32 s78, 256
    s_mov_b32 s79, 0x00020000
    v_and_b32 v34, 7, v1
    v_lshlrev_b32 v34, 2, v34
    s_mov_b32 s61, 0
K1_SPOLL:
    buffer_load_dword v35, v34, s[76:79], 0 offen sc1
    s_add_u32 s61, s61, 1
    s_waitcnt vmcnt(0)
    v_cmp_ne_u32 vcc, 32, v35
    s_nop 4
    s_cbranch_vccz K1_SPOLLOK
    s_sleep 16
    s_cmp_lt_u32 s61, 0x4000
    s_cbranch_scc1 K1_SPOLL
K1_SPOLLOK:
    s_mov_b32 s61, 0
    s_movk_i32 s62, 256
    s_mov_b32 s63, 13599232
P1_DONE:
    s_mov_b32 s12, s38
    s_and_b32 s13, s39, 0xffff
    s_mov_b32 s14, 2621440
    s_mov_b32 s15, 0x00020000
    v_lshlrev_b32 v2, 4, v1
    v_add_u32 v3, 4096, v2
    s_and_b32 s46, s2, 7
    s_lshr_b32 s47, s2, 3
    s_and_b32 s41, s46, 3
    s_lshl_b32 s41, s41, 3
    s_and_b32 s48, s47, 7
    s_add_u32 s41, s41, s48
    s_lshr_b32 s42, s46, 2
    s_lshl_b32 s42, s42, 2
    s_lshr_b32 s48, s47, 3
    s_add_u32 s42, s42, s48
    s_mul_i32 s50, s41, 303104
    s_mul_i32 s51, s42, 378880
    s_add_u32 s51, s51, 10485760
    s_lshl_b32 s52, s41, 3
    s_add_u32 s52, s52, s42
    s_lshl_b32 s52, s52, 7
    s_add_u32 s52, s52, 13599232
    v_mov_b32 v20, 0
    s_mul_i32 s46, s41, 17480
    s_add_u32 s47, s46, 13110
    s_lshr_b32 s46, s46, 16
    s_lshr_b32 s47, s47, 16
    s_cmp_eq_u32 s46, s47
    s_cselect_b32 s53, 11, 22
    s_cmp_eq_u32 s40, 7
    s_cbranch_scc0 P2_NSMP
    buffer_load_dword v21, v20, s[20:23], s52 offen sc1
P2_NSMP:
    v_mov_b32 v32, 0
    v_mov_b32 v33, 0
    v_mov_b32 v34, 0
    v_mov_b32 v35, 0
    v_mov_b32 v36, 0
    v_mov_b32 v37, 0
    v_mov_b32 v38, 0
    v_mov_b32 v39, 0
    v_mov_b32 v40, 0
    v_mov_b32 v41, 0
    v_mov_b32 v42, 0
    v_mov_b32 v43, 0
    v_mov_b32 v44, 0
    v_mov_b32 v45, 0
    v_mov_b32 v46, 0
    v_mov_b32 v47, 0
    v_mov_b32 v48, 0
    v_mov_b32 v49, 0
    v_mov_b32 v50, 0
    v_mov_b32 v51, 0
    v_mov_b32 v52, 0
    v_mov_b32 v53, 0
    v_mov_b32 v54, 0
    v_mov_b32 v55, 0
    v_mov_b32 v56, 0
    v_mov_b32 v57, 0
    v_mov_b32 v58, 0
    v_mov_b32 v59, 0
    v_mov_b32 v60, 0
    v_mov_b32 v61, 0
    v_mov_b32 v62, 0
    v_mov_b32 v63, 0
    v_mov_b32 v64, 0
    v_mov_b32 v65, 0
    v_mov_b32 v66, 0
    v_mov_b32 v67, 0
    v_mov_b32 v68, 0
    v_mov_b32 v69, 0
    v_mov_b32 v70, 0
    v_mov_b32 v71, 0
    v_mov_b32 v72, 0
    v_mov_b32 v73, 0
    v_mov_b32 v74, 0
    v_mov_b32 v75, 0
    v_mov_b32 v76, 0
    v_mov_b32 v77, 0
    v_mov_b32 v78, 0
    v_mov_b32 v79, 0
    v_mov_b32 v80, 0
    v_mov_b32 v81, 0
    v_mov_b32 v82, 0
    v_mov_b32 v83, 0
    v_mov_b32 v84, 0
    v_mov_b32 v85, 0
    v_mov_b32 v86, 0
    v_mov_b32 v87, 0
    v_mov_b32 v88, 0
    v_mov_b32 v89, 0
    v_mov_b32 v90, 0
    v_mov_b32 v91, 0
    v_mov_b32 v92, 0
    v_mov_b32 v93, 0
    v_mov_b32 v94, 0
    v_mov_b32 v95, 0
    v_mov_b32 v96, 0
    v_mov_b32 v97, 0
    v_mov_b32 v98, 0
    v_mov_b32 v99, 0
    v_mov_b32 v100, 0
    v_mov_b32 v101, 0
    v_mov_b32 v102, 0
    v_mov_b32 v103, 0
    v_mov_b32 v104, 0
    v_mov_b32 v105, 0
    v_mov_b32 v106, 0
    v_mov_b32 v107, 0
    v_mov_b32 v108, 0
    v_mov_b32 v109, 0
    v_mov_b32 v110, 0
    v_mov_b32 v111, 0
    s_waitcnt vmcnt(0)
    s_barrier
    v_add_u32 v24, s61, v0
    v_lshlrev_b32 v24, 7, v24
    v_mov_b32 v25, 1
    v_cmp_gt_u32 vcc, s62, v0
    s_nop 4
    s_mov_b64 exec, vcc
    s_cbranch_execz P1_NOSIG
    buffer_atomic_add v25, v24, s[20:23], s63 offen sc1
P1_NOSIG:
    s_mov_b64 exec, -1
    s_cmp_eq_u32 s40, 7
    s_cbranch_scc0 P2_OKA
    s_mov_b32 s47, 0
    s_waitcnt vmcnt(0)
P2_POLLA:
    v_readfirstlane_b32 s46, v21
    s_cmp_ge_u32 s46, 31
    s_cbranch_scc1 P2_OKA
    s_sleep 2
    buffer_load_dword v21, v20, s[20:23], s52 offen offset:0 sc1
    s_add_u32 s47, s47, 1
    s_cmp_lt_u32 s47, 0x8000
    s_waitcnt vmcnt(0)
    s_cbranch_scc1 P2_POLLA
P2_OKA:
    s_barrier
    s_add_u32 s46, s40, 20
    s_lshl_b32 s43, s46, 12
    s_add_u32 s43, s43, s50
    buffer_load_dwordx4 v[112:115], v2, s[20:23], s43 offen offset:0 sc1
    buffer_load_dwordx4 v[116:119], v2, s[20:23], s43 offen offset:1024 sc1
    buffer_load_dwordx4 v[120:123], v2, s[20:23], s43 offen offset:2048 sc1
    buffer_load_dwordx4 v[124:127], v2, s[20:23], s43 offen offset:3072 sc1
    s_add_u32 s46, s40, 20
    s_mul_i32 s44, s46, 5120
    s_add_u32 s44, s44, s51
    buffer_load_dwordx4 v[128:131], v2, s[20:23], s44 offen offset:0 sc1
    buffer_load_dwordx4 v[132:135], v2, s[20:23], s44 offen offset:1024 sc1
    buffer_load_dwordx4 v[136:139], v2, s[20:23], s44 offen offset:2048 sc1
    buffer_load_dwordx4 v[140:143], v2, s[20:23], s44 offen offset:3072 sc1
    buffer_load_dwordx4 v[144:147], v3, s[20:23], s44 offen sc1
    s_add_u32 s46, s40, 28
    s_lshl_b32 s43, s46, 12
    s_add_u32 s43, s43, s50
    buffer_load_dwordx4 v[148:151], v2, s[20:23], s43 offen offset:0 sc1
    buffer_load_dwordx4 v[152:155], v2, s[20:23], s43 offen offset:1024 sc1
    buffer_load_dwordx4 v[156:159], v2, s[20:23], s43 offen offset:2048 sc1
    buffer_load_dwordx4 v[160:163], v2, s[20:23], s43 offen offset:3072 sc1
    s_add_u32 s46, s40, 28
    s_mul_i32 s44, s46, 5120
    s_add_u32 s44, s44, s51
    buffer_load_dwordx4 v[164:167], v2, s[20:23], s44 offen offset:0 sc1
    buffer_load_dwordx4 v[168:171], v2, s[20:23], s44 offen offset:1024 sc1
    buffer_load_dwordx4 v[172:175], v2, s[20:23], s44 offen offset:2048 sc1
    buffer_load_dwordx4 v[176:179], v2, s[20:23], s44 offen offset:3072 sc1
    buffer_load_dwordx4 v[180:183], v3, s[20:23], s44 offen sc1
    s_add_u32 s46, s40, 36
    s_lshl_b32 s43, s46, 12
    s_add_u32 s43, s43, s50
    buffer_load_dwordx4 v[184:187], v2, s[20:23], s43 offen offset:0 sc1
    buffer_load_dwordx4 v[188:191], v2, s[20:23], s43 offen offset:1024 sc1
    buffer_load_dwordx4 v[192:195], v2, s[20:23], s43 offen offset:2048 sc1
    buffer_load_dwordx4 v[196:199], v2, s[20:23], s43 offen offset:3072 sc1
    s_add_u32 s46, s40, 36
    s_mul_i32 s44, s46, 5120
    s_add_u32 s44, s44, s51
    buffer_load_dwordx4 v[200:203], v2, s[20:23], s44 offen offset:0 sc1
    buffer_load_dwordx4 v[204:207], v2, s[20:23], s44 offen offset:1024 sc1
    buffer_load_dwordx4 v[208:211], v2, s[20:23], s44 offen offset:2048 sc1
    buffer_load_dwordx4 v[212:215], v2, s[20:23], s44 offen offset:3072 sc1
    buffer_load_dwordx4 v[216:219], v3, s[20:23], s44 offen sc1
    s_add_u32 s46, s40, 44
    s_lshl_b32 s43, s46, 12
    s_add_u32 s43, s43, s50
    buffer_load_dwordx4 v[220:223], v2, s[20:23], s43 offen offset:0 sc1
    buffer_load_dwordx4 v[224:227], v2, s[20:23], s43 offen offset:1024 sc1
    buffer_load_dwordx4 v[228:231], v2, s[20:23], s43 offen offset:2048 sc1
    buffer_load_dwordx4 v[232:235], v2, s[20:23], s43 offen offset:3072 sc1
    s_add_u32 s46, s40, 44
    s_mul_i32 s44, s46, 5120
    s_add_u32 s44, s44, s51
    buffer_load_dwordx4 v[236:239], v2, s[20:23], s44 offen offset:0 sc1
    buffer_load_dwordx4 v[240:243], v2, s[20:23], s44 offen offset:1024 sc1
    buffer_load_dwordx4 v[244:247], v2, s[20:23], s44 offen offset:2048 sc1
    buffer_load_dwordx4 v[248:251], v2, s[20:23], s44 offen offset:3072 sc1
    buffer_load_dwordx4 v[252:255], v3, s[20:23], s44 offen sc1
    s_mov_b32 s46, 0xcccd
    s_mul_i32 s47, s41, 81920
    s_mul_i32 s48, s42, 160
    s_add_u32 s47, s47, s48
    s_movk_i32 s48, 1280
    v_add_u32 v10, 0, v0
    v_mul_lo_u32 v11, v10, s46
    v_lshrrev_b32 v11, 20, v11
    v_mul_u32_u24 v12, 20, v11
    v_sub_u32 v10, v10, v12
    v_bfe_u32 v13, v11, 1, 2
    v_xor_b32 v13, v13, v10
    v_mul_u32_u24 v12, 320, v11
    v_lshl_add_u32 v7, v13, 4, v12
    v_mul_lo_u32 v11, v11, s48
    v_lshl_add_u32 v11, v10, 3, v11
    v_add_u32 v4, s47, v11
    v_add_u32 v10, 512, v0
    v_mul_lo_u32 v11, v10, s46
    v_lshrrev_b32 v11, 20, v11
    v_mul_u32_u24 v12, 20, v11
    v_sub_u32 v10, v10, v12
    v_bfe_u32 v13, v11, 1, 2
    v_xor_b32 v13, v13, v10
    v_mul_u32_u24 v12, 320, v11
    v_lshl_add_u32 v8, v13, 4, v12
    v_mul_lo_u32 v11, v11, s48
    v_lshl_add_u32 v11, v10, 3, v11
    v_add_u32 v5, s47, v11
    v_add_u32 v10, 1024, v0
    v_mul_lo_u32 v11, v10, s46
    v_lshrrev_b32 v11, 20, v11
    v_mul_u32_u24 v12, 20, v11
    v_sub_u32 v10, v10, v12
    v_bfe_u32 v13, v11, 1, 2
    v_xor_b32 v13, v13, v10
    v_mul_u32_u24 v12, 320, v11
    v_lshl_add_u32 v9, v13, 4, v12
    v_mul_lo_u32 v11, v11, s48
    v_lshl_add_u32 v11, v10, 3, v11
    v_add_u32 v6, s47, v11
    s_waitcnt vmcnt(27)
    v_mfma_f32_16x16x32_bf16 v[32:35], v[128:131], v[112:115], v[32:35]
    v_mfma_f32_16x16x32_bf16 v[52:55], v[128:131], v[116:119], v[52:55]
    v_mfma_f32_16x16x32_bf16 v[72:75], v[128:131], v[120:123], v[72:75]
    v_mfma_f32_16x16x32_bf16 v[92:95], v[128:131], v[124:127], v[92:95]
    v_mfma_f32_16x16x32_bf16 v[36:39], v[132:135], v[112:115], v[36:39]
    v_mfma_f32_16x16x32_bf16 v[56:59], v[132:135], v[116:119], v[56:59]
    v_mfma_f32_16x16x32_bf16 v[76:79], v[132:135], v[120:123], v[76:79]
    v_mfma_f32_16x16x32_bf16 v[96:99], v[132:135], v[124:127], v[96:99]
    v_mfma_f32_16x16x32_bf16 v[40:43], v[136:139], v[112:115], v[40:43]
    v_mfma_f32_16x16x32_bf16 v[60:63], v[136:139], v[116:119], v[60:63]
    v_mfma_f32_16x16x32_bf16 v[80:83], v[136:139], v[120:123], v[80:83]
    v_mfma_f32_16x16x32_bf16 v[100:103], v[136:139], v[124:127], v[100:103]
    v_mfma_f32_16x16x32_bf16 v[44:47], v[140:143], v[112:115], v[44:47]
    v_mfma_f32_16x16x32_bf16 v[64:67], v[140:143], v[116:119], v[64:67]
    v_mfma_f32_16x16x32_bf16 v[84:87], v[140:143], v[120:123], v[84:87]
    v_mfma_f32_16x16x32_bf16 v[104:107], v[140:143], v[124:127], v[104:107]
    v_mfma_f32_16x16x32_bf16 v[48:51], v[144:147], v[112:115], v[48:51]
    v_mfma_f32_16x16x32_bf16 v[68:71], v[144:147], v[116:119], v[68:71]
    v_mfma_f32_16x16x32_bf16 v[88:91], v[144:147], v[120:123], v[88:91]
    v_mfma_f32_16x16x32_bf16 v[108:111], v[144:147], v[124:127], v[108:111]
    s_add_u32 s46, s40, 52
    s_lshl_b32 s43, s46, 12
    s_add_u32 s43, s43, s50
    buffer_load_dwordx4 v[112:115], v2, s[20:23], s43 offen offset:0 sc1
    buffer_load_dwordx4 v[116:119], v2, s[20:23], s43 offen offset:1024 sc1
    buffer_load_dwordx4 v[120:123], v2, s[20:23], s43 offen offset:2048 sc1
    buffer_load_dwordx4 v[124:127], v2, s[20:23], s43 offen offset:3072 sc1
    s_add_u32 s46, s40, 52
    s_mul_i32 s44, s46, 5120
    s_add_u32 s44, s44, s51
    buffer_load_dwordx4 v[128:131], v2, s[20:23], s44 offen offset:0 sc1
    buffer_load_dwordx4 v[132:135], v2, s[20:23], s44 offen offset:1024 sc1
    buffer_load_dwordx4 v[136:139], v2, s[20:23], s44 offen offset:2048 sc1
    buffer_load_dwordx4 v[140:143], v2, s[20:23], s44 offen offset:3072 sc1
    buffer_load_dwordx4 v[144:147], v3, s[20:23], s44 offen sc1
    s_waitcnt vmcnt(27)
    v_mfma_f32_16x16x32_bf16 v[32:35], v[164:167], v[148:151], v[32:35]
    v_mfma_f32_16x16x32_bf16 v[52:55], v[164:167], v[152:155], v[52:55]
    v_mfma_f32_16x16x32_bf16 v[72:75], v[164:167], v[156:159], v[72:75]
    v_mfma_f32_16x16x32_bf16 v[92:95], v[164:167], v[160:163], v[92:95]
    v_mfma_f32_16x16x32_bf16 v[36:39], v[168:171], v[148:151], v[36:39]
    v_mfma_f32_16x16x32_bf16 v[56:59], v[168:171], v[152:155], v[56:59]
    v_mfma_f32_16x16x32_bf16 v[76:79], v[168:171], v[156:159], v[76:79]
    v_mfma_f32_16x16x32_bf16 v[96:99], v[168:171], v[160:163], v[96:99]
    v_mfma_f32_16x16x32_bf16 v[40:43], v[172:175], v[148:151], v[40:43]
    v_mfma_f32_16x16x32_bf16 v[60:63], v[172:175], v[152:155], v[60:63]
    v_mfma_f32_16x16x32_bf16 v[80:83], v[172:175], v[156:159], v[80:83]
    v_mfma_f32_16x16x32_bf16 v[100:103], v[172:175], v[160:163], v[100:103]
    v_mfma_f32_16x16x32_bf16 v[44:47], v[176:179], v[148:151], v[44:47]
    v_mfma_f32_16x16x32_bf16 v[64:67], v[176:179], v[152:155], v[64:67]
    v_mfma_f32_16x16x32_bf16 v[84:87], v[176:179], v[156:159], v[84:87]
    v_mfma_f32_16x16x32_bf16 v[104:107], v[176:179], v[160:163], v[104:107]
    v_mfma_f32_16x16x32_bf16 v[48:51], v[180:183], v[148:151], v[48:51]
    v_mfma_f32_16x16x32_bf16 v[68:71], v[180:183], v[152:155], v[68:71]
    v_mfma_f32_16x16x32_bf16 v[88:91], v[180:183], v[156:159], v[88:91]
    v_mfma_f32_16x16x32_bf16 v[108:111], v[180:183], v[160:163], v[108:111]
    s_add_u32 s46, s40, 60
    s_lshl_b32 s43, s46, 12
    s_add_u32 s43, s43, s50
    buffer_load_dwordx4 v[148:151], v2, s[20:23], s43 offen offset:0 sc1
    buffer_load_dwordx4 v[152:155], v2, s[20:23], s43 offen offset:1024 sc1
    buffer_load_dwordx4 v[156:159], v2, s[20:23], s43 offen offset:2048 sc1
    buffer_load_dwordx4 v[160:163], v2, s[20:23], s43 offen offset:3072 sc1
    s_add_u32 s46, s40, 60
    s_mul_i32 s44, s46, 5120
    s_add_u32 s44, s44, s51
    buffer_load_dwordx4 v[164:167], v2, s[20:23], s44 offen offset:0 sc1
    buffer_load_dwordx4 v[168:171], v2, s[20:23], s44 offen offset:1024 sc1
    buffer_load_dwordx4 v[172:175], v2, s[20:23], s44 offen offset:2048 sc1
    buffer_load_dwordx4 v[176:179], v2, s[20:23], s44 offen offset:3072 sc1
    buffer_load_dwordx4 v[180:183], v3, s[20:23], s44 offen sc1
    s_waitcnt vmcnt(27)
    v_mfma_f32_16x16x32_bf16 v[32:35], v[200:203], v[184:187], v[32:35]
    v_mfma_f32_16x16x32_bf16 v[52:55], v[200:203], v[188:191], v[52:55]
    v_mfma_f32_16x16x32_bf16 v[72:75], v[200:203], v[192:195], v[72:75]
    v_mfma_f32_16x16x32_bf16 v[92:95], v[200:203], v[196:199], v[92:95]
    v_mfma_f32_16x16x32_bf16 v[36:39], v[204:207], v[184:187], v[36:39]
    v_mfma_f32_16x16x32_bf16 v[56:59], v[204:207], v[188:191], v[56:59]
    v_mfma_f32_16x16x32_bf16 v[76:79], v[204:207], v[192:195], v[76:79]
    v_mfma_f32_16x16x32_bf16 v[96:99], v[204:207], v[196:199], v[96:99]
    v_mfma_f32_16x16x32_bf16 v[40:43], v[208:211], v[184:187], v[40:43]
    v_mfma_f32_16x16x32_bf16 v[60:63], v[208:211], v[188:191], v[60:63]
    v_mfma_f32_16x16x32_bf16 v[80:83], v[208:211], v[192:195], v[80:83]
    v_mfma_f32_16x16x32_bf16 v[100:103], v[208:211], v[196:199], v[100:103]
    v_mfma_f32_16x16x32_bf16 v[44:47], v[212:215], v[184:187], v[44:47]
    v_mfma_f32_16x16x32_bf16 v[64:67], v[212:215], v[188:191], v[64:67]
    v_mfma_f32_16x16x32_bf16 v[84:87], v[212:215], v[192:195], v[84:87]
    v_mfma_f32_16x16x32_bf16 v[104:107], v[212:215], v[196:199], v[104:107]
    v_mfma_f32_16x16x32_bf16 v[48:51], v[216:219], v[184:187], v[48:51]
    v_mfma_f32_16x16x32_bf16 v[68:71], v[216:219], v[188:191], v[68:71]
    v_mfma_f32_16x16x32_bf16 v[88:91], v[216:219], v[192:195], v[88:91]
    v_mfma_f32_16x16x32_bf16 v[108:111], v[216:219], v[196:199], v[108:111]
    s_add_u32 s46, s40, 68
    s_cmp_lt_u32 s40, 6
    s_cselect_b32 s47, 0, 74
    s_sub_u32 s46, s46, s47
    s_mul_i32 s44, s46, 5120
    s_add_u32 s44, s44, s51
    buffer_load_dwordx4 v[200:203], v2, s[20:23], s44 offen offset:0 sc1
    buffer_load_dwordx4 v[204:207], v2, s[20:23], s44 offen offset:1024 sc1
    buffer_load_dwordx4 v[208:211], v2, s[20:23], s44 offen offset:2048 sc1
    buffer_load_dwordx4 v[212:215], v2, s[20:23], s44 offen offset:3072 sc1
    buffer_load_dwordx4 v[216:219], v3, s[20:23], s44 offen sc1
    s_waitcnt vmcnt(23)
    v_mfma_f32_16x16x32_bf16 v[32:35], v[236:239], v[220:223], v[32:35]
    v_mfma_f32_16x16x32_bf16 v[52:55], v[236:239], v[224:227], v[52:55]
    v_mfma_f32_16x16x32_bf16 v[72:75], v[236:239], v[228:231], v[72:75]
    v_mfma_f32_16x16x32_bf16 v[92:95], v[236:239], v[232:235], v[92:95]
    v_mfma_f32_16x16x32_bf16 v[36:39], v[240:243], v[220:223], v[36:39]
    v_mfma_f32_16x16x32_bf16 v[56:59], v[240:243], v[224:227], v[56:59]
    v_mfma_f32_16x16x32_bf16 v[76:79], v[240:243], v[228:231], v[76:79]
    v_mfma_f32_16x16x32_bf16 v[96:99], v[240:243], v[232:235], v[96:99]
    v_mfma_f32_16x16x32_bf16 v[40:43], v[244:247], v[220:223], v[40:43]
    v_mfma_f32_16x16x32_bf16 v[60:63], v[244:247], v[224:227], v[60:63]
    v_mfma_f32_16x16x32_bf16 v[80:83], v[244:247], v[228:231], v[80:83]
    v_mfma_f32_16x16x32_bf16 v[100:103], v[244:247], v[232:235], v[100:103]
    v_mfma_f32_16x16x32_bf16 v[44:47], v[248:251], v[220:223], v[44:47]
    v_mfma_f32_16x16x32_bf16 v[64:67], v[248:251], v[224:227], v[64:67]
    v_mfma_f32_16x16x32_bf16 v[84:87], v[248:251], v[228:231], v[84:87]
    v_mfma_f32_16x16x32_bf16 v[104:107], v[248:251], v[232:235], v[104:107]
    v_mfma_f32_16x16x32_bf16 v[48:51], v[252:255], v[220:223], v[48:51]
    v_mfma_f32_16x16x32_bf16 v[68:71], v[252:255], v[224:227], v[68:71]
    v_mfma_f32_16x16x32_bf16 v[88:91], v[252:255], v[228:231], v[88:91]
    v_mfma_f32_16x16x32_bf16 v[108:111], v[252:255], v[232:235], v[108:111]
    s_add_u32 s46, s40, 2
    s_mul_i32 s44, s46, 5120
    s_add_u32 s44, s44, s51
    buffer_load_dwordx4 v[236:239], v2, s[20:23], s44 offen offset:0 sc1
    buffer_load_dwordx4 v[240:243], v2, s[20:23], s44 offen offset:1024 sc1
    buffer_load_dwordx4 v[244:247], v2, s[20:23], s44 offen offset:2048 sc1
    buffer_load_dwordx4 v[248:251], v2, s[20:23], s44 offen offset:3072 sc1
    buffer_load_dwordx4 v[252:255], v3, s[20:23], s44 offen sc1
    buffer_load_dword v21, v20, s[20:23], s52 offen offset:4 sc1
    s_waitcnt vmcnt(20)
    v_mfma_f32_16x16x32_bf16 v[32:35], v[128:131], v[112:115], v[32:35]
    v_mfma_f32_16x16x32_bf16 v[52:55], v[128:131], v[116:119], v[52:55]
    v_mfma_f32_16x16x32_bf16 v[72:75], v[128:131], v[120:123], v[72:75]
    v_mfma_f32_16x16x32_bf16 v[92:95], v[128:131], v[124:127], v[92:95]
    v_mfma_f32_16x16x32_bf16 v[36:39], v[132:135], v[112:115], v[36:39]
    v_mfma_f32_16x16x32_bf16 v[56:59], v[132:135], v[116:119], v[56:59]
    v_mfma_f32_16x16x32_bf16 v[76:79], v[132:135], v[120:123], v[76:79]
    v_mfma_f32_16x16x32_bf16 v[96:99], v[132:135], v[124:127], v[96:99]
    v_mfma_f32_16x16x32_bf16 v[40:43], v[136:139], v[112:115], v[40:43]
    v_mfma_f32_16x16x32_bf16 v[60:63], v[136:139], v[116:119], v[60:63]
    v_mfma_f32_16x16x32_bf16 v[80:83], v[136:139], v[120:123], v[80:83]
    v_mfma_f32_16x16x32_bf16 v[100:103], v[136:139], v[124:127], v[100:103]
    v_mfma_f32_16x16x32_bf16 v[44:47], v[140:143], v[112:115], v[44:47]
    v_mfma_f32_16x16x32_bf16 v[64:67], v[140:143], v[116:119], v[64:67]
    v_mfma_f32_16x16x32_bf16 v[84:87], v[140:143], v[120:123], v[84:87]
    v_mfma_f32_16x16x32_bf16 v[104:107], v[140:143], v[124:127], v[104:107]
    v_mfma_f32_16x16x32_bf16 v[48:51], v[144:147], v[112:115], v[48:51]
    v_mfma_f32_16x16x32_bf16 v[68:71], v[144:147], v[116:119], v[68:71]
    v_mfma_f32_16x16x32_bf16 v[88:91], v[144:147], v[120:123], v[88:91]
    v_mfma_f32_16x16x32_bf16 v[108:111], v[144:147], v[124:127], v[108:111]
    s_add_u32 s46, s40, 10
    s_mul_i32 s44, s46, 5120
    s_add_u32 s44, s44, s51
    buffer_load_dwordx4 v[128:131], v2, s[20:23], s44 offen offset:0 sc1
    buffer_load_dwordx4 v[132:135], v2, s[20:23], s44 offen offset:1024 sc1
    buffer_load_dwordx4 v[136:139], v2, s[20:23], s44 offen offset:2048 sc1
    buffer_load_dwordx4 v[140:143], v2, s[20:23], s44 offen offset:3072 sc1
    buffer_load_dwordx4 v[144:147], v3, s[20:23], s44 offen sc1
    s_waitcnt vmcnt(16)
    v_mfma_f32_16x16x32_bf16 v[32:35], v[164:167], v[148:151], v[32:35]
    v_mfma_f32_16x16x32_bf16 v[52:55], v[164:167], v[152:155], v[52:55]
    v_mfma_f32_16x16x32_bf16 v[72:75], v[164:167], v[156:159], v[72:75]
    v_mfma_f32_16x16x32_bf16 v[92:95], v[164:167], v[160:163], v[92:95]
    v_mfma_f32_16x16x32_bf16 v[36:39], v[168:171], v[148:151], v[36:39]
    v_mfma_f32_16x16x32_bf16 v[56:59], v[168:171], v[152:155], v[56:59]
    v_mfma_f32_16x16x32_bf16 v[76:79], v[168:171], v[156:159], v[76:79]
    v_mfma_f32_16x16x32_bf16 v[96:99], v[168:171], v[160:163], v[96:99]
    v_mfma_f32_16x16x32_bf16 v[40:43], v[172:175], v[148:151], v[40:43]
    v_mfma_f32_16x16x32_bf16 v[60:63], v[172:175], v[152:155], v[60:63]
    v_mfma_f32_16x16x32_bf16 v[80:83], v[172:175], v[156:159], v[80:83]
    v_mfma_f32_16x16x32_bf16 v[100:103], v[172:175], v[160:163], v[100:103]
    v_mfma_f32_16x16x32_bf16 v[44:47], v[176:179], v[148:151], v[44:47]
    v_mfma_f32_16x16x32_bf16 v[64:67], v[176:179], v[152:155], v[64:67]
    v_mfma_f32_16x16x32_bf16 v[84:87], v[176:179], v[156:159], v[84:87]
    v_mfma_f32_16x16x32_bf16 v[104:107], v[176:179], v[160:163], v[104:107]
    v_mfma_f32_16x16x32_bf16 v[48:51], v[180:183], v[148:151], v[48:51]
    v_mfma_f32_16x16x32_bf16 v[68:71], v[180:183], v[152:155], v[68:71]
    v_mfma_f32_16x16x32_bf16 v[88:91], v[180:183], v[156:159], v[88:91]
    v_mfma_f32_16x16x32_bf16 v[108:111], v[180:183], v[160:163], v[108:111]
    s_cmp_lt_u32 s40, 2
    s_cbranch_scc0 K2_NB9
    s_add_u32 s46, s40, 18
    s_min_u32 s46, s46, 19
    s_mul_i32 s44, s46, 5120
    s_add_u32 s44, s44, s51
    buffer_load_dwordx4 v[164:167], v2, s[20:23], s44 offen offset:0 sc1
    buffer_load_dwordx4 v[168:171], v2, s[20:23], s44 offen offset:1024 sc1
    buffer_load_dwordx4 v[172:175], v2, s[20:23], s44 offen offset:2048 sc1
    buffer_load_dwordx4 v[176:179], v2, s[20:23], s44 offen offset:3072 sc1
    buffer_load_dwordx4 v[180:183], v3, s[20:23], s44 offen sc1
K2_NB9:
    s_mov_b32 s47, 0
    s_waitcnt vmcnt(5)
P2_POLLB:
    v_readfirstlane_b32 s46, v21
    s_cmp_ge_u32 s46, s53
    s_cbranch_scc1 P2_OKB
    s_sleep 8
    buffer_load_dword v21, v20, s[20:23], s52 offen offset:4 sc1
    s_add_u32 s47, s47, 1
    s_cmp_lt_u32 s47, 0x8000
    s_waitcnt vmcnt(0)
    s_cbranch_scc1 P2_POLLB
P2_OKB:
    s_cmp_lt_u32 s40, 2
    s_cbranch_scc0 K2_NA9
    s_add_u32 s46, s40, 18
    s_min_u32 s46, s46, 19
    s_lshl_b32 s43, s46, 12
    s_add_u32 s43, s43, s50
    buffer_load_dwordx4 v[148:151], v2, s[20:23], s43 offen offset:0 sc1
    buffer_load_dwordx4 v[152:155], v2, s[20:23], s43 offen offset:1024 sc1
    buffer_load_dwordx4 v[156:159], v2, s[20:23], s43 offen offset:2048 sc1
    buffer_load_dwordx4 v[160:163], v2, s[20:23], s43 offen offset:3072 sc1
K2_NA9:
    s_add_u32 s46, s40, 68
    s_cmp_lt_u32 s40, 6
    s_cselect_b32 s47, 0, 74
    s_sub_u32 s46, s46, s47
    s_lshl_b32 s43, s46, 12
    s_add_u32 s43, s43, s50
    buffer_load_dwordx4 v[184:187], v2, s[20:23], s43 offen offset:0 sc1
    buffer_load_dwordx4 v[188:191], v2, s[20:23], s43 offen offset:1024 sc1
    buffer_load_dwordx4 v[192:195], v2, s[20:23], s43 offen offset:2048 sc1
    buffer_load_dwordx4 v[196:199], v2, s[20:23], s43 offen offset:3072 sc1
    s_add_u32 s46, s40, 2
    s_lshl_b32 s43, s46, 12
    s_add_u32 s43, s43, s50
    buffer_load_dwordx4 v[220:223], v2, s[20:23], s43 offen offset:0 sc1
    buffer_load_dwordx4 v[224:227], v2, s[20:23], s43 offen offset:1024 sc1
    buffer_load_dwordx4 v[228:231], v2, s[20:23], s43 offen offset:2048 sc1
    buffer_load_dwordx4 v[232:235], v2, s[20:23], s43 offen offset:3072 sc1
    s_add_u32 s46, s40, 10
    s_lshl_b32 s43, s46, 12
    s_add_u32 s43, s43, s50
    buffer_load_dwordx4 v[112:115], v2, s[20:23], s43 offen offset:0 sc1
    buffer_load_dwordx4 v[116:119], v2, s[20:23], s43 offen offset:1024 sc1
    buffer_load_dwordx4 v[120:123], v2, s[20:23], s43 offen offset:2048 sc1
    buffer_load_dwordx4 v[124:127], v2, s[20:23], s43 offen offset:3072 sc1
    buffer_load_dwordx2 v[22:23], v4, s[8:11], 0 offen
    buffer_load_dwordx2 v[24:25], v5, s[8:11], 0 offen
    buffer_load_dwordx2 v[26:27], v6, s[8:11], 0 offen
    s_cmp_lt_u32 s40, 2
    s_cbranch_scc0 K2_NM9
    s_waitcnt vmcnt(15)
    v_mfma_f32_16x16x32_bf16 v[32:35], v[164:167], v[148:151], v[32:35]
    v_mfma_f32_16x16x32_bf16 v[52:55], v[164:167], v[152:155], v[52:55]
    v_mfma_f32_16x16x32_bf16 v[72:75], v[164:167], v[156:159], v[72:75]
    v_mfma_f32_16x16x32_bf16 v[92:95], v[164:167], v[160:163], v[92:95]
    v_mfma_f32_16x16x32_bf16 v[36:39], v[168:171], v[148:151], v[36:39]
    v_mfma_f32_16x16x32_bf16 v[56:59], v[168:171], v[152:155], v[56:59]
    v_mfma_f32_16x16x32_bf16 v[76:79], v[168:171], v[156:159], v[76:79]
    v_mfma_f32_16x16x32_bf16 v[96:99], v[168:171], v[160:163], v[96:99]
    v_mfma_f32_16x16x32_bf16 v[40:43], v[172:175], v[148:151], v[40:43]
    v_mfma_f32_16x16x32_bf16 v[60:63], v[172:175], v[152:155], v[60:63]
    v_mfma_f32_16x16x32_bf16 v[80:83], v[172:175], v[156:159], v[80:83]
    v_mfma_f32_16x16x32_bf16 v[100:103], v[172:175], v[160:163], v[100:103]
    v_mfma_f32_16x16x32_bf16 v[44:47], v[176:179], v[148:151], v[44:47]
    v_mfma_f32_16x16x32_bf16 v[64:67], v[176:179], v[152:155], v[64:67]
    v_mfma_f32_16x16x32_bf16 v[84:87], v[176:179], v[156:159], v[84:87]
    v_mfma_f32_16x16x32_bf16 v[104:107], v[176:179], v[160:163], v[104:107]
    v_mfma_f32_16x16x32_bf16 v[48:51], v[180:183], v[148:151], v[48:51]
    v_mfma_f32_16x16x32_bf16 v[68:71], v[180:183], v[152:155], v[68:71]
    v_mfma_f32_16x16x32_bf16 v[88:91], v[180:183], v[156:159], v[88:91]
    v_mfma_f32_16x16x32_bf16 v[108:111], v[180:183], v[160:163], v[108:111]
K2_NM9:
    s_waitcnt vmcnt(11)
    v_mfma_f32_16x16x32_bf16 v[32:35], v[200:203], v[184:187], v[32:35]
    v_mfma_f32_16x16x32_bf16 v[52:55], v[200:203], v[188:191], v[52:55]
    v_mfma_f32_16x16x32_bf16 v[72:75], v[200:203], v[192:195], v[72:75]
    v_mfma_f32_16x16x32_bf16 v[92:95], v[200:203], v[196:199], v[92:95]
    v_mfma_f32_16x16x32_bf16 v[36:39], v[204:207], v[184:187], v[36:39]
    v_mfma_f32_16x16x32_bf16 v[56:59], v[204:207], v[188:191], v[56:59]
    v_mfma_f32_16x16x32_bf16 v[76:79], v[204:207], v[192:195], v[76:79]
    v_mfma_f32_16x16x32_bf16 v[96:99], v[204:207], v[196:199], v[96:99]
    v_mfma_f32_16x16x32_bf16 v[40:43], v[208:211], v[184:187], v[40:43]
    v_mfma_f32_16x16x32_bf16 v[60:63], v[208:211], v[188:191], v[60:63]
    v_mfma_f32_16x16x32_bf16 v[80:83], v[208:211], v[192:195], v[80:83]
    v_mfma_f32_16x16x32_bf16 v[100:103], v[208:211], v[196:199], v[100:103]
    v_mfma_f32_16x16x32_bf16 v[44:47], v[212:215], v[184:187], v[44:47]
    v_mfma_f32_16x16x32_bf16 v[64:67], v[212:215], v[188:191], v[64:67]
    v_mfma_f32_16x16x32_bf16 v[84:87], v[212:215], v[192:195], v[84:87]
    v_mfma_f32_16x16x32_bf16 v[104:107], v[212:215], v[196:199], v[104:107]
    v_mfma_f32_16x16x32_bf16 v[48:51], v[216:219], v[184:187], v[48:51]
    v_mfma_f32_16x16x32_bf16 v[68:71], v[216:219], v[188:191], v[68:71]
    v_mfma_f32_16x16x32_bf16 v[88:91], v[216:219], v[192:195], v[88:91]
    v_mfma_f32_16x16x32_bf16 v[108:111], v[216:219], v[196:199], v[108:111]
    s_waitcnt vmcnt(7)
    v_mfma_f32_16x16x32_bf16 v[32:35], v[236:239], v[220:223], v[32:35]
    v_mfma_f32_16x16x32_bf16 v[52:55], v[236:239], v[224:227], v[52:55]
    v_mfma_f32_16x16x32_bf16 v[72:75], v[236:239], v[228:231], v[72:75]
    v_mfma_f32_16x16x32_bf16 v[92:95], v[236:239], v[232:235], v[92:95]
    v_mfma_f32_16x16x32_bf16 v[36:39], v[240:243], v[220:223], v[36:39]
    v_mfma_f32_16x16x32_bf16 v[56:59], v[240:243], v[224:227], v[56:59]
    v_mfma_f32_16x16x32_bf16 v[76:79], v[240:243], v[228:231], v[76:79]
    v_mfma_f32_16x16x32_bf16 v[96:99], v[240:243], v[232:235], v[96:99]
    v_mfma_f32_16x16x32_bf16 v[40:43], v[244:247], v[220:223], v[40:43]
    v_mfma_f32_16x16x32_bf16 v[60:63], v[244:247], v[224:227], v[60:63]
    v_mfma_f32_16x16x32_bf16 v[80:83], v[244:247], v[228:231], v[80:83]
    v_mfma_f32_16x16x32_bf16 v[100:103], v[244:247], v[232:235], v[100:103]
    v_mfma_f32_16x16x32_bf16 v[44:47], v[248:251], v[220:223], v[44:47]
    v_mfma_f32_16x16x32_bf16 v[64:67], v[248:251], v[224:227], v[64:67]
    v_mfma_f32_16x16x32_bf16 v[84:87], v[248:251], v[228:231], v[84:87]
    v_mfma_f32_16x16x32_bf16 v[104:107], v[248:251], v[232:235], v[104:107]
    v_mfma_f32_16x16x32_bf16 v[48:51], v[252:255], v[220:223], v[48:51]
    v_mfma_f32_16x16x32_bf16 v[68:71], v[252:255], v[224:227], v[68:71]
    v_mfma_f32_16x16x32_bf16 v[88:91], v[252:255], v[228:231], v[88:91]
    v_mfma_f32_16x16x32_bf16 v[108:111], v[252:255], v[232:235], v[108:111]
    s_waitcnt vmcnt(3)
    v_mfma_f32_16x16x32_bf16 v[32:35], v[128:131], v[112:115], v[32:35]
    v_mfma_f32_16x16x32_bf16 v[52:55], v[128:131], v[116:119], v[52:55]
    v_mfma_f32_16x16x32_bf16 v[72:75], v[128:131], v[120:123], v[72:75]
    v_mfma_f32_16x16x32_bf16 v[92:95], v[128:131], v[124:127], v[92:95]
    v_mfma_f32_16x16x32_bf16 v[36:39], v[132:135], v[112:115], v[36:39]
    v_mfma_f32_16x16x32_bf16 v[56:59], v[132:135], v[116:119], v[56:59]
    v_mfma_f32_16x16x32_bf16 v[76:79], v[132:135], v[120:123], v[76:79]
    v_mfma_f32_16x16x32_bf16 v[96:99], v[132:135], v[124:127], v[96:99]
    v_mfma_f32_16x16x32_bf16 v[40:43], v[136:139], v[112:115], v[40:43]
    v_mfma_f32_16x16x32_bf16 v[60:63], v[136:139], v[116:119], v[60:63]
    v_mfma_f32_16x16x32_bf16 v[80:83], v[136:139], v[120:123], v[80:83]
    v_mfma_f32_16x16x32_bf16 v[100:103], v[136:139], v[124:127], v[100:103]
    v_mfma_f32_16x16x32_bf16 v[44:47], v[140:143], v[112:115], v[44:47]
    v_mfma_f32_16x16x32_bf16 v[64:67], v[140:143], v[116:119], v[64:67]
    v_mfma_f32_16x16x32_bf16 v[84:87], v[140:143], v[120:123], v[84:87]
    v_mfma_f32_16x16x32_bf16 v[104:107], v[140:143], v[124:127], v[104:107]
    v_mfma_f32_16x16x32_bf16 v[48:51], v[144:147], v[112:115], v[48:51]
    v_mfma_f32_16x16x32_bf16 v[68:71], v[144:147], v[116:119], v[68:71]
    v_mfma_f32_16x16x32_bf16 v[88:91], v[144:147], v[120:123], v[88:91]
    v_mfma_f32_16x16x32_bf16 v[108:111], v[144:147], v[124:127], v[108:111]
K2_RED:
    v_and_b32 v10, 15, v1
    v_bfe_u32 v12, v1, 1, 2
    v_mul_u32_u24 v10, 320, v10
    v_lshrrev_b32 v11, 4, v1
    v_xor_b32 v11, v11, v12
    v_lshl_add_u32 v10, v11, 4, v10
    s_mul_i32 s46, s40, 20480
    v_add_u32 v10, s46, v10
    s_nop 7
    ds_write_b128 v10, v[32:35] offset:0
    ds_write_b128 v10, v[36:39] offset:64
    ds_write_b128 v10, v[40:43] offset:128
    ds_write_b128 v10, v[44:47] offset:192
    ds_write_b128 v10, v[48:51] offset:256
    ds_write_b128 v10, v[52:55] offset:5120
    ds_write_b128 v10, v[56:59] offset:5184
    ds_write_b128 v10, v[60:63] offset:5248
    ds_write_b128 v10, v[64:67] offset:5312
    ds_write_b128 v10, v[68:71] offset:5376
    ds_write_b128 v10, v[72:75] offset:10240
    ds_write_b128 v10, v[76:79] offset:10304
    ds_write_b128 v10, v[80:83] offset:10368
    ds_write_b128 v10, v[84:87] offset:10432
    ds_write_b128 v10, v[88:91] offset:10496
    ds_write_b128 v10, v[92:95] offset:15360
    ds_write_b128 v10, v[96:99] offset:15424
    ds_write_b128 v10, v[100:103] offset:15488
    ds_write_b128 v10, v[104:107] offset:15552
    ds_write_b128 v10, v[108:111] offset:15616
    s_waitcnt lgkmcnt(0)
    s_barrier
    v_add_u32 v10, 61440, v7
    v_add_u32 v11, 122880, v7
    ds_read_b128 v[32:35], v7 offset:0
    ds_read_b128 v[36:39], v7 offset:20480
    ds_read_b128 v[40:43], v7 offset:40960
    ds_read_b128 v[44:47], v10 offset:0
    ds_read_b128 v[48:51], v10 offset:20480
    ds_read_b128 v[52:55], v10 offset:40960
    ds_read_b128 v[56:59], v11 offset:0
    ds_read_b128 v[60:63], v11 offset:20480
    s_waitcnt vmcnt(0)
    v_lshlrev_b32 v64, 16, v22
    v_and_b32 v65, 0xffff0000, v22
    v_lshlrev_b32 v66, 16, v23
    v_and_b32 v67, 0xffff0000, v23
    s_waitcnt lgkmcnt(6)
    v_add_f32 v32, v32, v36
    v_add_f32 v33, v33, v37
    v_add_f32 v34, v34, v38
    v_add_f32 v35, v35, v39
    s_waitcnt lgkmcnt(4)
    v_add_f32 v40, v40, v44
    v_add_f32 v41, v41, v45
    v_add_f32 v42, v42, v46
    v_add_f32 v43, v43, v47
    s_waitcnt lgkmcnt(2)
    v_add_f32 v48, v48, v52
    v_add_f32 v49, v49, v53
    v_add_f32 v50, v50, v54
    v_add_f32 v51, v51, v55
    s_waitcnt lgkmcnt(0)
    v_add_f32 v56, v56, v60
    v_add_f32 v57, v57, v61
    v_add_f32 v58, v58, v62
    v_add_f32 v59, v59, v63
    v_add_f32 v32, v32, v40
    v_add_f32 v48, v48, v56
    v_add_f32 v33, v33, v41
    v_add_f32 v49, v49, v57
    v_add_f32 v34, v34, v42
    v_add_f32 v50, v50, v58
    v_add_f32 v35, v35, v43
    v_add_f32 v51, v51, v59
    v_add_f32 v32, v32, v48
    v_add_f32 v33, v33, v49
    v_add_f32 v34, v34, v50
    v_add_f32 v35, v35, v51
    v_add_f32 v32, v32, v64
    v_add_f32 v33, v33, v65
    v_add_f32 v34, v34, v66
    v_add_f32 v35, v35, v67
    v_cvt_pk_bf16_f32 v68, v32, v33
    v_cvt_pk_bf16_f32 v69, v34, v35
    buffer_store_dwordx2 v[68:69], v4, s[12:15], 0 offen
    v_add_u32 v10, 61440, v8
    v_add_u32 v11, 122880, v8
    ds_read_b128 v[32:35], v8 offset:0
    ds_read_b128 v[36:39], v8 offset:20480
    ds_read_b128 v[40:43], v8 offset:40960
    ds_read_b128 v[44:47], v10 offset:0
    ds_read_b128 v[48:51], v10 offset:20480
    ds_read_b128 v[52:55], v10 offset:40960
    ds_read_b128 v[56:59], v11 offset:0
    ds_read_b128 v[60:63], v11 offset:20480
    s_nop 0
    v_lshlrev_b32 v64, 16, v24
    v_and_b32 v65, 0xffff0000, v24
    v_lshlrev_b32 v66, 16, v25
    v_and_b32 v67, 0xffff0000, v25
    s_waitcnt lgkmcnt(6)
    v_add_f32 v32, v32, v36
    v_add_f32 v33, v33, v37
    v_add_f32 v34, v34, v38
    v_add_f32 v35, v35, v39
    s_waitcnt lgkmcnt(4)
    v_add_f32 v40, v40, v44
    v_add_f32 v41, v41, v45
    v_add_f32 v42, v42, v46
    v_add_f32 v43, v43, v47
    s_waitcnt lgkmcnt(2)
    v_add_f32 v48, v48, v52
    v_add_f32 v49, v49, v53
    v_add_f32 v50, v50, v54
    v_add_f32 v51, v51, v55
    s_waitcnt lgkmcnt(0)
    v_add_f32 v56, v56, v60
    v_add_f32 v57, v57, v61
    v_add_f32 v58, v58, v62
    v_add_f32 v59, v59, v63
    v_add_f32 v32, v32, v40
    v_add_f32 v48, v48, v56
    v_add_f32 v33, v33, v41
    v_add_f32 v49, v49, v57
    v_add_f32 v34, v34, v42
    v_add_f32 v50, v50, v58
    v_add_f32 v35, v35, v43
    v_add_f32 v51, v51, v59
    v_add_f32 v32, v32, v48
    v_add_f32 v33, v33, v49
    v_add_f32 v34, v34, v50
    v_add_f32 v35, v35, v51
    v_add_f32 v32, v32, v64
    v_add_f32 v33, v33, v65
    v_add_f32 v34, v34, v66
    v_add_f32 v35, v35, v67
    v_cvt_pk_bf16_f32 v70, v32, v33
    v_cvt_pk_bf16_f32 v71, v34, v35
    buffer_store_dwordx2 v[70:71], v5, s[12:15], 0 offen
    s_cmp_lt_u32 s40, 4
    s_cbranch_scc0 K2_FIN
    v_add_u32 v10, 61440, v9
    v_add_u32 v11, 122880, v9
    ds_read_b128 v[32:35], v9 offset:0
    ds_read_b128 v[36:39], v9 offset:20480
    ds_read_b128 v[40:43], v9 offset:40960
    ds_read_b128 v[44:47], v10 offset:0
    ds_read_b128 v[48:51], v10 offset:20480
    ds_read_b128 v[52:55], v10 offset:40960
    ds_read_b128 v[56:59], v11 offset:0
    ds_read_b128 v[60:63], v11 offset:20480
    s_nop 0
    v_lshlrev_b32 v64, 16, v26
    v_and_b32 v65, 0xffff0000, v26
    v_lshlrev_b32 v66, 16, v27
    v_and_b32 v67, 0xffff0000, v27
    s_waitcnt lgkmcnt(6)
    v_add_f32 v32, v32, v36
    v_add_f32 v33, v33, v37
    v_add_f32 v34, v34, v38
    v_add_f32 v35, v35, v39
    s_waitcnt lgkmcnt(4)
    v_add_f32 v40, v40, v44
    v_add_f32 v41, v41, v45
    v_add_f32 v42, v42, v46
    v_add_f32 v43, v43, v47
    s_waitcnt lgkmcnt(2)
    v_add_f32 v48, v48, v52
    v_add_f32 v49, v49, v53
    v_add_f32 v50, v50, v54
    v_add_f32 v51, v51, v55
    s_waitcnt lgkmcnt(0)
    v_add_f32 v56, v56, v60
    v_add_f32 v57, v57, v61
    v_add_f32 v58, v58, v62
    v_add_f32 v59, v59, v63
    v_add_f32 v32, v32, v40
    v_add_f32 v48, v48, v56
    v_add_f32 v33, v33, v41
    v_add_f32 v49, v49, v57
    v_add_f32 v34, v34, v42
    v_add_f32 v50, v50, v58
    v_add_f32 v35, v35, v43
    v_add_f32 v51, v51, v59
    v_add_f32 v32, v32, v48
    v_add_f32 v33, v33, v49
    v_add_f32 v34, v34, v50
    v_add_f32 v35, v35, v51
    v_add_f32 v32, v32, v64
    v_add_f32 v33, v33, v65
    v_add_f32 v34, v34, v66
    v_add_f32 v35, v35, v67
    v_cvt_pk_bf16_f32 v72, v32, v33
    v_cvt_pk_bf16_f32 v73, v34, v35
    buffer_store_dwordx2 v[72:73], v6, s[12:15], 0 offen
K2_FIN:
K1_END:
    s_endpgm
.section .rodata,"a"
.p2align 6
.amdhsa_kernel parallel_sum__sliding_local_dilated__glu_gated_geglu__prompt_kernel
  .amdhsa_next_free_vgpr 256
  .amdhsa_next_free_sgpr 102
  .amdhsa_accum_offset 256
  .amdhsa_group_segment_fixed_size 0
  .amdhsa_kernarg_size 80
  .amdhsa_user_sgpr_count 2
  .amdhsa_user_sgpr_kernarg_segment_ptr 1
  .amdhsa_system_sgpr_workgroup_id_x 1
.end_amdhsa_kernel
```
